```python
import torch

def _softmax(x, axis=-1):
    return torch.softmax(x, dim=axis)
def _gelu(x):
    return torch.nn.functional.gelu(x, approximate="tanh")
def _silu(x):
    return torch.nn.functional.silu(x)
def _sigmoid(x):
    return torch.sigmoid(x)
def _layernorm(x, axis=-1, eps=1e-5):
    m = x.mean(dim=axis, keepdim=True)
    v = x.var(dim=axis, keepdim=True, unbiased=False)
    return (x - m) / torch.sqrt(v + eps)
def _scatter_add(tgt, idx, src, axis=0):
    return tgt.clone().index_add_(axis, idx, src)
def _segment_sum(src, seg, n):
    out = torch.zeros((n,) + src.shape[1:], dtype=src.dtype)
    return out.index_add_(0, seg, src)
def _pad(x, pw):
    flat = tuple(v for pair in reversed(pw) for v in pair)
    return torch.nn.functional.pad(x, flat)

kernel_name = 'sequential_preLN__sliding_block_cached__dense_activation_gelu__decode'

def setup_inputs():

    _w = (lambda a: (lambda t: t.to(torch.bfloat16) if t.is_floating_point() else t)(torch.as_tensor(a)))
    def _A_setup():
        B, Sq, D = 1, 1, 512
        Hq, Hkv, Sk, Dh = 32, 32, 16384, 128
        assert Hq % Hkv == 0, (Hq, Hkv)
        return {
            "x": _w((lambda *s: torch.randn(*s, dtype=torch.bfloat16) * 0.1)(B, Sq, D)),
            "k_cache": _w((lambda *s: torch.randn(*s, dtype=torch.bfloat16) * 1.6)(B, Hkv, Sk, Dh)),
            "v_cache": _w((lambda *s: torch.randn(*s, dtype=torch.bfloat16) * 1.6)(B, Hkv, Sk, Dh)),
            "wq": _w((lambda *s: torch.randn(*s, dtype=torch.bfloat16) * 1.6)(D, Hq * Dh) * (D ** -0.5)),
            "wo": _w((lambda *s: torch.randn(*s, dtype=torch.bfloat16) * 1.6)(Hq * Dh, D) * ((Hq * Dh) ** -0.5)),
        }
    _A_in = _A_setup()

    def _B_setup():
        B, S, D, F = 1, 1, 512, 1376
        return {
            "x": _w((lambda *s: torch.randn(*s, dtype=torch.bfloat16) * 0.1)(B, S, D)),
            "w1": _w((lambda *s: torch.randn(*s, dtype=torch.bfloat16) * 3.2)(D, F) * (D ** -0.5)),
            "b1": _w((lambda *s: torch.randn(*s, dtype=torch.bfloat16) * 3.2)(F) * 0.01),
            "w2": _w((lambda *s: torch.randn(*s, dtype=torch.bfloat16) * 3.2)(F, D) * (F ** -0.5)),
            "b2": _w((lambda *s: torch.randn(*s, dtype=torch.bfloat16) * 3.2)(D) * 0.01),
        }
    _B_in = _B_setup()

    return {
        "A_x": _A_in["x"],
        "A_k_cache": _A_in["k_cache"],
        "A_v_cache": _A_in["v_cache"],
        "A_wq": _A_in["wq"],
        "A_wo": _A_in["wo"],
        "B_x": _B_in["x"],
        "B_w1": _B_in["w1"],
        "B_b1": _B_in["b1"],
        "B_w2": _B_in["w2"],
        "B_b2": _B_in["b2"],
    }

def reference(A_x, A_k_cache, A_v_cache, A_wq, A_wo, B_x, B_w1, B_b1, B_w2, B_b2):
    def _A_ref(x, k_cache, v_cache, wq, wo):
        B, Sq, D = x.shape
        Hq, Dh = 32, 128
        Hkv, Sk = k_cache.shape[1], k_cache.shape[2]
        W = min(4096, max(256, Sk // 4))
        rep = Hq // Hkv
        q = (lambda x, *d: x.permute(*d))((x @ wq).reshape(B, Sq, Hq, Dh), 0, 2, 1, 3)
        k = (lambda x, n, axis: torch.repeat_interleave(x, n, dim=axis))(k_cache[:, :, Sk - W:, :], rep, axis=1)
        v = (lambda x, n, axis: torch.repeat_interleave(x, n, dim=axis))(v_cache[:, :, Sk - W:, :], rep, axis=1)
        scores = torch.einsum("bhqd,bhkd->bhqk", q, k) * (Dh ** -0.5)
        p = _softmax(scores, axis=-1)
        o = torch.einsum("bhqk,bhkd->bhqd", p, v)
        return (lambda x, *d: x.permute(*d))(o, 0, 2, 1, 3).reshape(B, Sq, Hq * Dh) @ wo

    def _B_ref(x, w1, b1, w2, b2):
        h = torch.einsum("bsd,df->bsf", x, w1) + b1
        h = _gelu(h)
        return torch.einsum("bsf,fd->bsd", h, w2) + b2

    x = A_x
    h = x + _A_ref(_layernorm(x, axis=-1), A_k_cache, A_v_cache, A_wq, A_wo)
    h2 = h + _B_ref(_layernorm(h, axis=-1), B_w1, B_b1, B_w2, B_b2)
    return h2
```

```asm
; @launch grid=(256,1,1) block=(768,1,1) lds=86016
.amdgcn_target "amdgcn-amd-amdhsa--gfx950"
.text
.globl sequential_preLN__sliding_block_cached__dense_activation_gelu__decode_kernel
.p2align 8
.type sequential_preLN__sliding_block_cached__dense_activation_gelu__decode_kernel,@function
sequential_preLN__sliding_block_cached__dense_activation_gelu__decode_kernel:
    v_lshrrev_b32 v1, 6, v0
    s_cmp_ge_u32 s2, 256
    s_cbranch_scc1 L_end
    v_readfirstlane_b32 s3, v1
    v_mov_b32 v4, -1
    v_mov_b32 v5, -1
    v_mov_b32 v6, -1
    v_mov_b32 v7, -1
    s_cmp_gt_u32 s3, 8
    s_cbranch_scc0 L_karg
    v_lshlrev_b32 v2, 4, v0
    v_subrev_u32 v2, 9216, v2
    ds_write_b128 v2, v[4:7] offset:0
    ds_write_b128 v2, v[4:7] offset:3072
    ds_write_b128 v2, v[4:7] offset:6144
    s_waitcnt lgkmcnt(0)
L_karg:
    s_load_dwordx16 s[16:31], s[0:1], 0
    s_load_dwordx8 s[32:39], s[0:1], 64
    s_load_dwordx2 s[40:41], s[0:1], 96
    s_barrier
    v_and_b32 v0, 63, v0
    s_and_b32 s12, s2, 7
    s_lshl_b32 s4, s12, 2
    s_lshr_b32 s5, s2, 6
    s_add_u32 s4, s4, s5
    s_bfe_u32 s5, s2, 0x30003
    s_lshl_b32 s6, s4, 3
    s_add_u32 s6, s6, s5
    s_lshr_b32 s60, s2, 4
    s_lshl_b32 s11, s60, 3
    s_add_u32 s11, s11, s12
    s_and_b32 s60, s60, 7
    s_lshl_b32 s61, s60, 4
    s_lshr_b32 s62, s4, 1
    s_add_u32 s61, s61, s62
    s_lshl_b32 s61, s61, 8
    s_mul_i32 s50, s62, 4352
    s_bitcmp1_b32 s5, 0
    s_cselect_b32 s11, 64, s11
    s_mov_b32 s15, 0
    s_mov_b32 s14, 262144
    v_lshlrev_b32 v1, 4, v0
    s_and_b32 s10, s3, 3
    s_mov_b32 s47, 0x20000
    s_mov_b32 s43, s47
    s_mov_b32 s46, s47
    s_mov_b32 s42, 0x400000
    s_cmp_lt_u32 s3, 4
    s_cbranch_scc0 L_kv
    s_setprio 3
    v_lshrrev_b32 v2, 4, v0
    s_lshl_b32 s7, s5, 6
    s_lshl_b32 s8, s10, 4
    s_add_u32 s7, s7, s8
    s_lshl_b32 s8, s7, 1
    v_lshl_add_u32 v3, v2, 3, s8
    v_lshlrev_b32 v2, 15, v2
    v_and_b32 v6, 15, v0
    v_lshl_add_u32 v2, v6, 4, v2
    s_lshl_b32 s7, s7, 13
    s_lshl_b32 s8, s4, 8
    s_add_u32 s7, s7, s8
    s_mov_b32 s46, 123136
    s_movk_i32 s8, 0x2000
    s_movk_i32 s9, 0x4000
    s_movk_i32 s13, 0x6000
    s_waitcnt lgkmcnt(0)
    global_load_dwordx4 v[28:31], v1, s[16:17]
    global_load_dwordx2 v[8:9], v3, s[16:17]
    s_add_u32 s44, s22, s7
    s_addc_u32 s45, s23, 0
    buffer_load_dwordx4 v[32:35], v2, s[44:47], 0 offen nt
    buffer_load_dwordx4 v[36:39], v2, s[44:47], s8 offen nt
    buffer_load_dwordx4 v[40:43], v2, s[44:47], s9 offen nt
    buffer_load_dwordx4 v[44:47], v2, s[44:47], s13 offen nt
    s_branch L_hq
L_kv:
    s_cmp_eq_u32 s3, 8
    s_cbranch_scc0 L_kv2
    s_setprio 3
    s_lshl_b32 s8, s6, 9
    s_add_u32 s49, s61, 393216
    s_mov_b32 exec_hi, 0
    s_and_b32 s12, s6, 15
    s_lshl_b32 s48, s12, 8
    s_add_u32 s9, s50, 131072
    s_add_u32 s48, s48, s9
    v_add_u32 v2, s48, v1
    s_lshl_b32 s48, s12, 4
    s_add_u32 s48, s48, s9
    s_addk_i32 s48, 0x1000
    v_writelane_b32 v2, s48, 16
    s_lshl_b32 s7, s6, 7
    s_add_u32 s7, s7, 589824
    v_writelane_b32 v2, s7, 17
    s_waitcnt lgkmcnt(0)
    buffer_store_dwordx4 v[4:7], v1, s[40:43], s8 offen sc1
    s_mov_b32 exec_lo, 0x3ffff
    buffer_store_dwordx4 v[4:7], v2, s[40:43], 0 offen sc1
    s_bitcmp1_b32 s5, 0
    s_cbranch_scc0 L_v0e
    s_mov_b32 exec_lo, 0xffff
    buffer_store_dwordx4 v[4:7], v1, s[40:43], s49 offen sc1
L_v0e:
    s_mov_b64 exec, -1
    s_cmp_lt_u32 s11, 43
    s_cbranch_scc0 L_kv2
    v_lshrrev_b32 v2, 3, v0
    v_mul_u32_u24 v2, 5504, v2
    v_and_b32 v3, 7, v0
    v_lshl_add_u32 v2, v3, 4, v2
    s_lshl_b32 s8, s11, 7
    s_add_u32 s8, s8, 458752
    s_add_u32 s9, s8, 44032
    buffer_store_dwordx4 v[4:7], v2, s[40:43], s8 offen sc1
    buffer_store_dwordx4 v[4:7], v2, s[40:43], s9 offen sc1
L_kv2:
    s_lshl_b32 s7, s4, 2
    s_add_u32 s7, s7, 3
    s_lshl_b32 s7, s7, 20
    s_lshr_b32 s8, s2, 3
    s_add_u32 s8, s8, s2
    s_add_u32 s8, s8, s10
    s_and_b32 s8, s8, 3
    s_lshl_b32 s52, s5, 2
    s_add_u32 s8, s8, s52
    s_and_b32 s52, s2, 0xc0
    s_add_u32 s8, s8, s52
    s_lshl_b32 s8, s8, 12
    s_mov_b32 s52, 128000
    s_mov_b32 s53, 0xfffff
    s_mov_b32 s46, 0x100000
    s_cmp_ge_u32 s3, 8
    s_waitcnt lgkmcnt(0)
    s_cselect_b32 s44, s20, s18
    s_cselect_b32 s45, s21, s19
    s_cbranch_scc1 L_vpre
    s_setprio 2
L_stream:
    s_add_u32 s44, s44, s7
    s_addc_u32 s45, s45, 0
    buffer_load_dwordx4 v[32:35], v1, s[44:47], s8 offen nt
    s_addk_i32 s8, 0x400
    buffer_load_dwordx4 v[36:39], v1, s[44:47], s8 offen nt
    s_addk_i32 s8, 0x400
    buffer_load_dwordx4 v[40:43], v1, s[44:47], s8 offen nt
    s_addk_i32 s8, 0x400
    buffer_load_dwordx4 v[44:47], v1, s[44:47], s8 offen nt
    s_add_u32 s8, s8, s52
    s_and_b32 s8, s8, s53
    buffer_load_dwordx4 v[48:51], v1, s[44:47], s8 offen nt
    s_addk_i32 s8, 0x400
    buffer_load_dwordx4 v[52:55], v1, s[44:47], s8 offen nt
    s_addk_i32 s8, 0x400
    buffer_load_dwordx4 v[56:59], v1, s[44:47], s8 offen nt
    s_addk_i32 s8, 0x400
    buffer_load_dwordx4 v[60:63], v1, s[44:47], s8 offen nt
    s_add_u32 s8, s8, s52
    s_and_b32 s8, s8, s53
    buffer_load_dwordx4 v[64:67], v1, s[44:47], s8 offen nt
    s_addk_i32 s8, 0x400
    buffer_load_dwordx4 v[68:71], v1, s[44:47], s8 offen nt
    s_addk_i32 s8, 0x400
    buffer_load_dwordx4 v[72:75], v1, s[44:47], s8 offen nt
    s_addk_i32 s8, 0x400
    buffer_load_dwordx4 v[76:79], v1, s[44:47], s8 offen nt
    s_add_u32 s8, s8, s52
    s_and_b32 s8, s8, s53
    buffer_load_dwordx4 v[80:83], v1, s[44:47], s8 offen nt
    s_addk_i32 s8, 0x400
    buffer_load_dwordx4 v[84:87], v1, s[44:47], s8 offen nt
    s_addk_i32 s8, 0x400
    buffer_load_dwordx4 v[88:91], v1, s[44:47], s8 offen nt
    s_addk_i32 s8, 0x400
    buffer_load_dwordx4 v[92:95], v1, s[44:47], s8 offen nt
    s_add_u32 s8, s8, s52
    s_and_b32 s8, s8, s53
    buffer_load_dwordx4 v[96:99], v1, s[44:47], s8 offen nt
    s_addk_i32 s8, 0x400
    buffer_load_dwordx4 v[100:103], v1, s[44:47], s8 offen nt
    s_addk_i32 s8, 0x400
    buffer_load_dwordx4 v[104:107], v1, s[44:47], s8 offen nt
    s_addk_i32 s8, 0x400
    buffer_load_dwordx4 v[108:111], v1, s[44:47], s8 offen nt
    s_add_u32 s8, s8, s52
    s_and_b32 s8, s8, s53
    buffer_load_dwordx4 v[112:115], v1, s[44:47], s8 offen nt
    s_addk_i32 s8, 0x400
    buffer_load_dwordx4 v[116:119], v1, s[44:47], s8 offen nt
    s_addk_i32 s8, 0x400
    buffer_load_dwordx4 v[120:123], v1, s[44:47], s8 offen nt
    s_addk_i32 s8, 0x400
    buffer_load_dwordx4 v[124:127], v1, s[44:47], s8 offen nt
    s_add_u32 s8, s8, s52
    s_and_b32 s8, s8, s53
    buffer_load_dwordx4 v[128:131], v1, s[44:47], s8 offen nt
    s_addk_i32 s8, 0x400
    buffer_load_dwordx4 v[132:135], v1, s[44:47], s8 offen nt
    s_addk_i32 s8, 0x400
    buffer_load_dwordx4 v[136:139], v1, s[44:47], s8 offen nt
    s_addk_i32 s8, 0x400
    buffer_load_dwordx4 v[140:143], v1, s[44:47], s8 offen nt
    s_add_u32 s8, s8, s52
    s_and_b32 s8, s8, s53
    buffer_load_dwordx4 v[144:147], v1, s[44:47], s8 offen nt
    s_addk_i32 s8, 0x400
    buffer_load_dwordx4 v[148:151], v1, s[44:47], s8 offen nt
    s_addk_i32 s8, 0x400
    buffer_load_dwordx4 v[152:155], v1, s[44:47], s8 offen nt
    s_addk_i32 s8, 0x400
    buffer_load_dwordx4 v[156:159], v1, s[44:47], s8 offen nt
    s_cmp_ge_u32 s3, 8
    s_cbranch_scc1 L_vwave
    s_branch L_kwave
L_vpre:
    s_cmp_eq_u32 s3, 8
    s_cbranch_scc0 L_vpre2
    s_lshl_b32 s48, s4, 3
    s_getreg_b32 s13, hwreg(HW_REG_XCC_ID, 0, 3)
    s_lshl_b32 s13, s13, 2
    s_lshl_b32 s13, 1, s13
    s_mov_b32 s12, 1
    v_mov_b32 v8, 0
    v_lshlrev_b32 v9, 7, v0
    s_lshl_b32 s9, s4, 10
    s_add_u32 s9, s9, 589824
    s_waitcnt vmcnt(0)
    s_atomic_add_x2 s[12:13], s[38:39], s48 glc
    ds_write_b32 v8, v8 offset:304
    s_waitcnt lgkmcnt(0)
    s_and_b32 s12, s12, 7
    s_cmp_lg_u32 s12, 7
    s_cbranch_scc1 L_walk_ret
    s_mov_b64 exec, 0xff
    buffer_store_dword v8, v9, s[40:43], s9 offen sc1
    ds_write_b32 v8, v8 offset:312
    s_branch L_walk_ret
L_vpre2:
    s_mov_b64 exec, 0
    s_cmp_eq_u32 s3, 9
    s_cbranch_scc1 L_seg0
    s_cmp_eq_u32 s3, 10
    s_cbranch_scc1 L_seg1
    s_branch L_seg2
L_walk_ret:
    s_mov_b64 exec, -1
    s_setprio 1
    s_branch L_stream
L_hq:
L_seg0:
L_pad0:
    s_cbranch_execz L_pad1
    v_and_b32 v2, 15, v0
    v_and_b32 v3, 1, v0
    v_lshlrev_b32 v3, 4, v3
    v_mov_b32 v100, 0xffff
    v_lshlrev_b32 v3, v3, v100
    v_lshrrev_b32 v2, 1, v2
    v_cmp_eq_u32 vcc, 0, v2
    s_nop 1
    v_cndmask_b32 v100, 0, v3, vcc
    v_cmp_eq_u32 vcc, 1, v2
    s_nop 1
    v_cndmask_b32 v101, 0, v3, vcc
    v_cmp_eq_u32 vcc, 2, v2
    s_nop 1
    v_cndmask_b32 v102, 0, v3, vcc
    v_cmp_eq_u32 vcc, 3, v2
    s_nop 1
    v_cndmask_b32 v103, 0, v3, vcc
    s_waitcnt vmcnt(5)
    v_lshlrev_b32 v16, 16, v28
    v_and_b32 v17, 0xffff0000, v28
    v_lshlrev_b32 v18, 16, v29
    v_and_b32 v19, 0xffff0000, v29
    v_lshlrev_b32 v20, 16, v30
    v_and_b32 v21, 0xffff0000, v30
    v_lshlrev_b32 v22, 16, v31
L_pad1:
    s_cbranch_execz L_pad2
    v_and_b32 v23, 0xffff0000, v31
    v_pk_add_f32 v[24:25], v[16:17], v[18:19]
    v_pk_add_f32 v[26:27], v[20:21], v[22:23]
    v_pk_add_f32 v[24:25], v[24:25], v[26:27]
    v_add_f32 v24, v24, v25
    s_nop 1
    v_add_f32_dpp v24, v24, v24 quad_perm:[1,0,3,2] row_mask:0xf bank_mask:0xf
    s_nop 1
    v_add_f32_dpp v24, v24, v24 quad_perm:[2,3,0,1] row_mask:0xf bank_mask:0xf
    s_nop 1
    v_add_f32_dpp v24, v24, v24 row_ror:4 row_mask:0xf bank_mask:0xf
    s_nop 1
    v_add_f32_dpp v24, v24, v24 row_ror:8 row_mask:0xf bank_mask:0xf
    v_mov_b32 v25, v24
    s_nop 1
    v_permlane16_swap_b32 v24, v25
    v_add_f32 v24, v24, v25
    v_mov_b32 v25, v24
    s_nop 1
    v_permlane32_swap_b32 v24, v25
    v_add_f32 v24, v24, v25
    v_mul_f32 v24, 0x3b000000, v24
L_pad2:
    s_cbranch_execz L_pad3
    v_sub_f32 v16, v16, v24
    v_sub_f32 v17, v17, v24
    v_sub_f32 v18, v18, v24
    v_sub_f32 v19, v19, v24
    v_sub_f32 v20, v20, v24
    v_sub_f32 v21, v21, v24
    v_sub_f32 v22, v22, v24
    v_sub_f32 v23, v23, v24
    v_mul_f32 v26, v16, v16
    v_mul_f32 v27, v17, v17
    v_fmac_f32 v26, v18, v18
    v_fmac_f32 v27, v19, v19
    v_fmac_f32 v26, v20, v20
    v_fmac_f32 v27, v21, v21
    v_fmac_f32 v26, v22, v22
    v_fmac_f32 v27, v23, v23
    v_add_f32 v26, v26, v27
    s_nop 1
    v_add_f32_dpp v26, v26, v26 quad_perm:[1,0,3,2] row_mask:0xf bank_mask:0xf
    s_nop 1
    v_add_f32_dpp v26, v26, v26 quad_perm:[2,3,0,1] row_mask:0xf bank_mask:0xf
    s_nop 1
    v_add_f32_dpp v26, v26, v26 row_ror:4 row_mask:0xf bank_mask:0xf
    s_nop 1
    v_add_f32_dpp v26, v26, v26 row_ror:8 row_mask:0xf bank_mask:0xf
    v_mov_b32 v25, v26
    s_nop 1
L_pad3:
    s_cbranch_execz L_pad4
    v_permlane16_swap_b32 v26, v25
    v_add_f32 v26, v26, v25
    v_mov_b32 v25, v26
    s_nop 1
    v_permlane32_swap_b32 v26, v25
    v_add_f32 v26, v26, v25
    v_mul_f32 v26, 0x3b000000, v26
    v_cvt_pk_bf16_f32 v24, 0, v24
    v_cvt_pk_bf16_f32 v26, 0, v26
    v_add_f32 v26, 0x3727c5ac, v26
    v_cvt_pk_bf16_f32 v26, 0, v26
    v_sqrt_f32 v26, v26
    s_waitcnt vmcnt(4)
    v_lshlrev_b32 v12, 16, v8
    v_and_b32 v13, 0xffff0000, v8
    v_lshlrev_b32 v14, 16, v9
    v_and_b32 v15, 0xffff0000, v9
    v_cvt_pk_bf16_f32 v26, 0, v26
    v_rcp_f32 v26, v26
    v_sub_f32 v12, v12, v24
    v_sub_f32 v13, v13, v24
    v_sub_f32 v14, v14, v24
    v_sub_f32 v15, v15, v24
L_pad4:
    s_cbranch_execz L_pad5
    v_cvt_pk_bf16_f32 v8, v12, v13
    v_cvt_pk_bf16_f32 v9, v14, v15
    v_lshlrev_b32 v12, 16, v8
    v_and_b32 v13, 0xffff0000, v8
    v_lshlrev_b32 v14, 16, v9
    v_and_b32 v15, 0xffff0000, v9
    v_mul_f32 v12, v12, v26
    v_mul_f32 v13, v13, v26
    v_mul_f32 v14, v14, v26
    v_mul_f32 v15, v15, v26
    v_cvt_pk_bf16_f32 v12, v12, v12
    v_cvt_pk_bf16_f32 v13, v13, v13
    v_cvt_pk_bf16_f32 v14, v14, v14
    v_cvt_pk_bf16_f32 v15, v15, v15
    v_and_b32 v104, v12, v100
    v_and_b32 v105, v12, v101
    v_and_b32 v106, v12, v102
    v_and_b32 v107, v12, v103
    v_and_b32 v108, v13, v100
    v_and_b32 v109, v13, v101
    v_and_b32 v110, v13, v102
    v_and_b32 v111, v13, v103
    v_and_b32 v112, v14, v100
L_pad5:
    s_cbranch_execz L_pad6
    v_and_b32 v113, v14, v101
    v_and_b32 v114, v14, v102
    v_and_b32 v115, v14, v103
    v_and_b32 v116, v15, v100
    v_and_b32 v117, v15, v101
    v_and_b32 v118, v15, v102
    v_and_b32 v119, v15, v103
    v_and_b32 v3, 15, v0
    v_lshlrev_b32 v3, 5, v3
    v_lshrrev_b32 v2, 4, v0
    v_lshl_add_u32 v3, v2, 4, v3
    s_lshl_b32 s7, s10, 9
    v_add_u32 v2, s7, v3
    s_waitcnt vmcnt(3)
    v_mfma_f32_16x16x32_bf16 v[96:99], v[104:107], v[32:35], 0
    s_waitcnt vmcnt(2)
    v_mfma_f32_16x16x32_bf16 v[96:99], v[108:111], v[36:39], v[96:99]
    s_waitcnt vmcnt(1)
    v_mfma_f32_16x16x32_bf16 v[96:99], v[112:115], v[40:43], v[96:99]
    s_waitcnt vmcnt(0)
    v_mfma_f32_16x16x32_bf16 v[96:99], v[116:119], v[44:47], v[96:99]
    s_nop 7
    v_min_u32 v96, -2, v96
    v_min_u32 v97, -2, v97
    v_min_u32 v98, -2, v98
    v_min_u32 v99, -2, v99
L_pad6:
    s_cbranch_execz L_pad7
    s_mov_b32 exec_hi, 0
    ds_write_b128 v2, v[96:99] offset:1024
    s_mov_b64 exec, -1
    s_cmp_eq_u32 s3, 3
    s_cbranch_scc0 L_hodd
    v_lshlrev_b32 v2, 3, v0
    v_mov_b32 v3, 0
    s_lshl_b32 s7, s6, 9
L_qw_1:
    ds_read_b64 v[4:5], v2 offset:1024
    ds_read_b64 v[6:7], v2 offset:1536
    ds_read_b64 v[8:9], v2 offset:2048
    ds_read_b64 v[10:11], v2 offset:2560
    ds_read_b32 v12, v3 offset:304
    s_add_u32 s15, s15, 1
    s_cmp_gt_u32 s15, s14
    s_cbranch_scc1 L_exit
    s_waitcnt lgkmcnt(0)
    v_max3_u32 v13, v4, v5, v6
    v_max3_u32 v13, v13, v7, v8
    v_max3_u32 v13, v13, v9, v10
    v_max3_u32 v13, v13, v11, v12
L_pad7:
    s_cbranch_execz L_pad8
    v_cmp_eq_u32 vcc, -1, v13
    s_cbranch_vccnz L_qw_1
    v_pk_add_f32 v[4:5], v[4:5], v[6:7]
    v_pk_add_f32 v[8:9], v[8:9], v[10:11]
    v_pk_add_f32 v[4:5], v[4:5], v[8:9]
    v_min_u32 v4, -2, v4
    v_min_u32 v5, -2, v5
    buffer_store_dwordx2 v[4:5], v2, s[40:43], s7 offen sc1
L_h3ml:
    s_and_b32 s12, s6, 15
    s_lshl_b32 s7, s12, 4
    s_add_u32 s7, s7, s50
    s_add_u32 s7, s7, 135168
    v_mov_b32 v2, 0
    v_and_b32 v3, 3, v0
    v_lshlrev_b32 v3, 3, v3
L_hms_2:
    s_sleep 4
    ds_read_b64 v[4:5], v3 offset:256
    ds_read_b32 v7, v2 offset:308
    s_add_u32 s15, s15, 1
    s_cmp_gt_u32 s15, s14
    s_cbranch_scc1 L_exit
    s_waitcnt lgkmcnt(0)
    v_max3_u32 v6, v4, v5, v7
L_pad8:
    s_cbranch_execz L_pad9
    v_cmp_eq_u32 vcc, -1, v6
    s_cbranch_vccnz L_hms_2
    v_max_f32_dpp v12, v4, v4 quad_perm:[1,0,3,2] row_mask:0xf bank_mask:0xf
    s_nop 1
    v_max_f32_dpp v12, v12, v12 quad_perm:[2,3,0,1] row_mask:0xf bank_mask:0xf
    v_sub_f32 v13, v4, v12
    v_mul_f32 v13, 0x3fb8aa3b, v13
    v_exp_f32 v13, v13
    s_nop 0
    v_mul_f32 v13, v13, v5
    s_nop 1
    v_add_f32_dpp v13, v13, v13 quad_perm:[1,0,3,2] row_mask:0xf bank_mask:0xf
    s_nop 1
    v_add_f32_dpp v13, v13, v13 quad_perm:[2,3,0,1] row_mask:0xf bank_mask:0xf
    v_min_u32 v12, -2, v12
    v_min_u32 v13, -2, v13
    v_cmp_eq_u32 vcc, 0, v7
    s_mov_b64 exec, 1
    s_cbranch_vccnz L_ml_far
    buffer_store_dwordx2 v[12:13], v2, s[40:43], s7 offen
    s_branch L_ml_done
L_ml_far:
    buffer_store_dwordx2 v[12:13], v2, s[40:43], s7 offen sc1
L_ml_done:
    s_mov_b64 exec, -1
    s_branch L_h_done
L_hodd:
L_pad9:
    s_cbranch_execz L_pad10
    s_cmp_eq_u32 s3, 0
    s_cbranch_scc0 L_h1
    v_mov_b32 v3, 0
    s_lshl_b32 s48, s4, 12
    s_lshl_b32 s7, s6, 7
    s_add_u32 s7, s7, 589824
L_h0c_3:
    s_sleep 2
    ds_read_b32 v12, v3 offset:304
    s_add_u32 s15, s15, 1
    s_cmp_gt_u32 s15, s14
    s_cbranch_scc1 L_exit
    s_waitcnt lgkmcnt(0)
    v_cmp_eq_u32 vcc, -1, v12
    s_cbranch_vccnz L_h0c_3
L_go_4:
    s_sleep 4
    s_load_dword s8, s[40:41], s7 glc
    ds_read_b32 v12, v3 offset:312
    s_add_u32 s15, s15, 1
    s_cmp_gt_u32 s15, s14
    s_cbranch_scc1 L_exit
    s_waitcnt lgkmcnt(0)
    v_cmp_eq_u32 vcc, 0, v12
    s_cbranch_vccnz L_go_ok
    s_cmp_lg_u32 s8, 0
    s_cbranch_scc1 L_go_4
L_go_ok:
    ds_write_b32 v3, v3 offset:312
L_qp_5:
L_pad10:
    s_cbranch_execz L_pad11
    buffer_load_dwordx4 v[8:11], v1, s[40:43], s48 offen offset:0 sc1
    buffer_load_dwordx4 v[12:15], v1, s[40:43], s48 offen offset:1024 sc1
    buffer_load_dwordx4 v[16:19], v1, s[40:43], s48 offen offset:2048 sc1
    buffer_load_dwordx4 v[20:23], v1, s[40:43], s48 offen offset:3072 sc1
    s_add_u32 s15, s15, 1
    s_cmp_gt_u32 s15, s14
    s_cbranch_scc1 L_exit
    s_waitcnt vmcnt(0)
    v_max3_u32 v4, v8, v9, v10
    v_max3_u32 v4, v4, v11, v12
    v_max3_u32 v4, v4, v13, v14
    v_max3_u32 v4, v4, v15, v16
    v_max3_u32 v4, v4, v17, v18
    v_max3_u32 v4, v4, v19, v20
    v_max3_u32 v4, v4, v21, v22
    v_max_u32 v4, v4, v23
    v_cmp_eq_u32 vcc, -1, v4
    s_cbranch_vccz L_qpd_6
    s_mov_b64 exec, vcc
    s_branch L_qp_5
L_qpd_6:
L_pad11:
    s_cbranch_execz L_pad12
    s_mov_b64 exec, -1
    v_pk_add_f32 v[8:9], v[8:9], v[12:13]
    v_pk_add_f32 v[10:11], v[10:11], v[14:15]
    v_pk_add_f32 v[16:17], v[16:17], v[20:21]
    v_pk_add_f32 v[18:19], v[18:19], v[22:23]
    v_pk_add_f32 v[8:9], v[8:9], v[16:17]
    v_pk_add_f32 v[10:11], v[10:11], v[18:19]
    v_and_b32 v6, 31, v0
    v_lshlrev_b32 v6, 3, v6
    v_permlane32_swap_b32 v8, v10
    v_permlane32_swap_b32 v9, v11
    v_pk_add_f32 v[8:9], v[8:9], v[10:11]
    v_lshrrev_b32 v7, 5, v0
    v_cvt_pk_bf16_f32 v4, v8, v9
    v_min_u32 v4, -2, v4
    v_lshl_add_u32 v6, v7, 2, v6
    ds_write_b32 v6, v4 offset:0
    s_branch L_h_done
L_h1:
    s_cmp_eq_u32 s3, 1
    s_cbranch_scc0 L_h2
    v_and_b32 v8, 31, v0
L_pad12:
    s_cbranch_execz L_pad13
    v_lshlrev_b32 v9, 3, v8
    s_getreg_b32 s12, hwreg(HW_REG_XCC_ID, 0, 3)
    s_lshl_b32 s12, s12, 2
    s_lshl_b32 s12, 8, s12
    v_mov_b32 v2, 0
L_h1g_7:
    s_sleep 8
    ds_read_b32 v7, v2 offset:312
    s_add_u32 s15, s15, 1
    s_cmp_gt_u32 s15, s14
    s_cbranch_scc1 L_exit
    s_waitcnt lgkmcnt(0)
    v_cmp_eq_u32 vcc, -1, v7
    s_cbranch_vccnz L_h1g_7
L_mf_8:
    s_sleep 16
    global_load_dwordx2 v[6:7], v9, s[38:39] sc1
    s_add_u32 s15, s15, 1
    s_cmp_gt_u32 s15, s14
    s_cbranch_scc1 L_exit
    s_waitcnt vmcnt(0)
    v_max_u32 v6, 1, v6
    v_and_b32 v6, 7, v6
    v_cmp_ne_u32 vcc, 0, v6
    s_cbranch_vccnz L_mf_8
    v_cmp_eq_u32 vcc, s12, v7
    s_lshl_b32 s8, s62, 1
    s_lshr_b32 s8, vcc_lo, s8
    s_and_b32 s8, s8, 3
    s_cmp_eq_u32 s8, 3
    s_cselect_b32 s8, 1, 0
L_pad13:
    s_cbranch_execz L_pad14
    v_mov_b32 v13, s8
    ds_write_b32 v2, v13 offset:308
    s_bitcmp1_b32 s5, 0
    s_cbranch_scc0 L_h_done
    s_add_u32 s50, s50, 135168
    v_lshlrev_b32 v3, 2, v0
L_mlg_9:
    s_sleep 4
    ds_read_b32 v4, v2 offset:320
    s_add_u32 s15, s15, 1
    s_cmp_gt_u32 s15, s14
    s_cbranch_scc1 L_exit
    s_waitcnt lgkmcnt(0)
    v_cmp_eq_u32 vcc, -1, v4
    s_cbranch_vccnz L_mlg_9
    s_mov_b64 exec, 0xffff
    v_mov_b32 v4, -1
    v_mov_b32 v5, -1
L_mp_10:
    buffer_load_dwordx2 v[4:5], v1, s[40:43], s50 offen sc1
    s_add_u32 s15, s15, 1
    s_cmp_gt_u32 s15, s14
    s_cbranch_scc1 L_exit
    s_sleep 12
    s_waitcnt vmcnt(6)
    v_max_u32 v10, v4, v5
    v_cmp_eq_u32 vcc, -1, v10
    s_cbranch_vccnz L_mp_10
L_pad14:
    s_cbranch_execz L_pad15
    v_max_f32_dpp v10, v4, v4 quad_perm:[1,0,3,2] row_mask:0xf bank_mask:0xf
    s_nop 1
    v_max_f32_dpp v10, v10, v10 quad_perm:[2,3,0,1] row_mask:0xf bank_mask:0xf
    s_nop 1
    v_max_f32_dpp v10, v10, v10 row_half_mirror row_mask:0xf bank_mask:0xf
    v_sub_f32 v11, v4, v10
    v_mul_f32 v11, 0x3fb8aa3b, v11
    v_exp_f32 v11, v11
    s_nop 0
    v_mul_f32 v12, v11, v5
    s_nop 1
    v_add_f32_dpp v12, v12, v12 quad_perm:[1,0,3,2] row_mask:0xf bank_mask:0xf
    s_nop 1
    v_add_f32_dpp v12, v12, v12 quad_perm:[2,3,0,1] row_mask:0xf bank_mask:0xf
    s_nop 1
    v_add_f32_dpp v12, v12, v12 row_half_mirror row_mask:0xf bank_mask:0xf
    v_rcp_f32 v12, v12
    s_nop 0
    v_mul_f32 v11, v11, v12
    v_min_u32 v11, -2, v11
    ds_write_b32 v3, v11 offset:384
    s_branch L_exit
L_kwave:
    v_mov_b32 v8, 0
L_pad15:
    s_cbranch_execz L_pad16
    v_mov_b32 v9, 0
    v_mov_b32 v10, 0
    v_mov_b32 v11, 0
    v_mov_b32 v12, 0
    v_mov_b32 v13, 0
    v_mov_b32 v14, 0
    v_mov_b32 v15, 0
    v_mov_b32 v16, 0
    v_mov_b32 v17, 0
    v_mov_b32 v18, 0
    v_mov_b32 v19, 0
    v_mov_b32 v20, 0
    v_mov_b32 v21, 0
    v_mov_b32 v22, 0
    v_mov_b32 v23, 0
    v_and_b32 v2, 15, v0
    v_lshlrev_b32 v2, 4, v2
L_kq_11:
    s_sleep 2
    ds_read_b128 v[4:7], v2 offset:0
    s_add_u32 s15, s15, 1
    s_cmp_gt_u32 s15, s14
    s_cbranch_scc1 L_exit
    s_waitcnt lgkmcnt(0)
    v_max3_u32 v3, v4, v5, v6
    v_max_u32 v3, v3, v7
    v_cmp_eq_u32 vcc, -1, v3
    s_cbranch_vccnz L_kq_11
    s_waitcnt vmcnt(28)
    v_dot2c_f32_bf16 v8, v32, v4
L_pad16:
    s_cbranch_execz L_pad17
    v_dot2c_f32_bf16 v9, v36, v4
    v_dot2c_f32_bf16 v10, v40, v4
    v_dot2c_f32_bf16 v11, v44, v4
    v_dot2c_f32_bf16 v8, v33, v5
    v_dot2c_f32_bf16 v9, v37, v5
    v_dot2c_f32_bf16 v10, v41, v5
    v_dot2c_f32_bf16 v11, v45, v5
    v_dot2c_f32_bf16 v8, v34, v6
    v_dot2c_f32_bf16 v9, v38, v6
    v_dot2c_f32_bf16 v10, v42, v6
    v_dot2c_f32_bf16 v11, v46, v6
    v_dot2c_f32_bf16 v8, v35, v7
    v_dot2c_f32_bf16 v9, v39, v7
    v_dot2c_f32_bf16 v10, v43, v7
    v_dot2c_f32_bf16 v11, v47, v7
    s_waitcnt vmcnt(24)
    v_dot2c_f32_bf16 v12, v48, v4
    v_dot2c_f32_bf16 v13, v52, v4
    v_dot2c_f32_bf16 v14, v56, v4
    v_dot2c_f32_bf16 v15, v60, v4
    v_dot2c_f32_bf16 v12, v49, v5
    v_dot2c_f32_bf16 v13, v53, v5
    v_dot2c_f32_bf16 v14, v57, v5
    v_dot2c_f32_bf16 v15, v61, v5
    v_dot2c_f32_bf16 v12, v50, v6
    v_dot2c_f32_bf16 v13, v54, v6
    v_dot2c_f32_bf16 v14, v58, v6
    v_dot2c_f32_bf16 v15, v62, v6
    v_dot2c_f32_bf16 v12, v51, v7
    v_dot2c_f32_bf16 v13, v55, v7
    v_dot2c_f32_bf16 v14, v59, v7
L_pad17:
    s_cbranch_execz L_pad18
    v_dot2c_f32_bf16 v15, v63, v7
    s_waitcnt vmcnt(20)
    v_dot2c_f32_bf16 v16, v64, v4
    v_dot2c_f32_bf16 v17, v68, v4
    v_dot2c_f32_bf16 v18, v72, v4
    v_dot2c_f32_bf16 v19, v76, v4
    v_dot2c_f32_bf16 v16, v65, v5
    v_dot2c_f32_bf16 v17, v69, v5
    v_dot2c_f32_bf16 v18, v73, v5
    v_dot2c_f32_bf16 v19, v77, v5
    v_dot2c_f32_bf16 v16, v66, v6
    v_dot2c_f32_bf16 v17, v70, v6
    v_dot2c_f32_bf16 v18, v74, v6
    v_dot2c_f32_bf16 v19, v78, v6
    v_dot2c_f32_bf16 v16, v67, v7
    v_dot2c_f32_bf16 v17, v71, v7
    v_dot2c_f32_bf16 v18, v75, v7
    v_dot2c_f32_bf16 v19, v79, v7
    s_waitcnt vmcnt(16)
    v_dot2c_f32_bf16 v20, v80, v4
    v_dot2c_f32_bf16 v21, v84, v4
    v_dot2c_f32_bf16 v22, v88, v4
    v_dot2c_f32_bf16 v23, v92, v4
    v_dot2c_f32_bf16 v20, v81, v5
    v_dot2c_f32_bf16 v21, v85, v5
    v_dot2c_f32_bf16 v22, v89, v5
    v_dot2c_f32_bf16 v23, v93, v5
    v_dot2c_f32_bf16 v20, v82, v6
    v_dot2c_f32_bf16 v21, v86, v6
    v_dot2c_f32_bf16 v22, v90, v6
    v_dot2c_f32_bf16 v23, v94, v6
L_pad18:
    s_cbranch_execz L_pad19
    v_dot2c_f32_bf16 v20, v83, v7
    v_dot2c_f32_bf16 v21, v87, v7
    v_dot2c_f32_bf16 v22, v91, v7
    v_dot2c_f32_bf16 v23, v95, v7
    v_add_f32_dpp v8, v8, v8 row_ror:8 row_mask:0xf bank_mask:0x3
    v_add_f32_dpp v9, v9, v9 row_ror:8 row_mask:0xf bank_mask:0x3
    v_add_f32_dpp v8, v10, v10 row_ror:8 row_mask:0xf bank_mask:0xc
    v_add_f32_dpp v9, v11, v11 row_ror:8 row_mask:0xf bank_mask:0xc
    v_add_f32_dpp v12, v12, v12 row_ror:8 row_mask:0xf bank_mask:0x3
    v_add_f32_dpp v13, v13, v13 row_ror:8 row_mask:0xf bank_mask:0x3
    v_add_f32_dpp v12, v14, v14 row_ror:8 row_mask:0xf bank_mask:0xc
    v_add_f32_dpp v13, v15, v15 row_ror:8 row_mask:0xf bank_mask:0xc
    v_add_f32_dpp v16, v16, v16 row_ror:8 row_mask:0xf bank_mask:0x3
    v_add_f32_dpp v17, v17, v17 row_ror:8 row_mask:0xf bank_mask:0x3
    v_add_f32_dpp v16, v18, v18 row_ror:8 row_mask:0xf bank_mask:0xc
    v_add_f32_dpp v17, v19, v19 row_ror:8 row_mask:0xf bank_mask:0xc
    v_add_f32_dpp v20, v20, v20 row_ror:8 row_mask:0xf bank_mask:0x3
    v_add_f32_dpp v21, v21, v21 row_ror:8 row_mask:0xf bank_mask:0x3
L_pad19:
    s_cbranch_execz L_pad20
    v_add_f32_dpp v20, v22, v22 row_ror:8 row_mask:0xf bank_mask:0xc
    v_add_f32_dpp v21, v23, v23 row_ror:8 row_mask:0xf bank_mask:0xc
    v_add_f32_dpp v24, v8, v8 row_half_mirror row_mask:0xf bank_mask:0x5
    v_add_f32_dpp v24, v9, v9 row_half_mirror row_mask:0xf bank_mask:0xa
    v_add_f32_dpp v25, v12, v12 row_half_mirror row_mask:0xf bank_mask:0x5
    v_add_f32_dpp v25, v13, v13 row_half_mirror row_mask:0xf bank_mask:0xa
    v_add_f32_dpp v26, v16, v16 row_half_mirror row_mask:0xf bank_mask:0x5
    v_add_f32_dpp v26, v17, v17 row_half_mirror row_mask:0xf bank_mask:0xa
    v_add_f32_dpp v27, v20, v20 row_half_mirror row_mask:0xf bank_mask:0x5
    v_add_f32_dpp v27, v21, v21 row_half_mirror row_mask:0xf bank_mask:0xa
    v_mov_b32 v8, 0
    v_mov_b32 v9, 0
    v_mov_b32 v10, 0
    v_mov_b32 v11, 0
    v_mov_b32 v12, 0
    v_mov_b32 v13, 0
    v_mov_b32 v14, 0
    v_mov_b32 v15, 0
    v_mov_b32 v16, 0
    v_mov_b32 v17, 0
L_pad20:
    s_cbranch_execz L_pad21
    v_mov_b32 v18, 0
    v_mov_b32 v19, 0
    v_mov_b32 v20, 0
    v_mov_b32 v21, 0
    v_mov_b32 v22, 0
    v_mov_b32 v23, 0
    v_add_f32_dpp v24, v24, v24 quad_perm:[1,0,3,2] row_mask:0xf bank_mask:0xf
    v_add_f32_dpp v25, v25, v25 quad_perm:[1,0,3,2] row_mask:0xf bank_mask:0xf
    v_add_f32_dpp v26, v26, v26 quad_perm:[1,0,3,2] row_mask:0xf bank_mask:0xf
    v_add_f32_dpp v27, v27, v27 quad_perm:[1,0,3,2] row_mask:0xf bank_mask:0xf
    v_add_f32_dpp v24, v24, v24 quad_perm:[2,3,0,1] row_mask:0xf bank_mask:0xf
    v_add_f32_dpp v25, v25, v25 quad_perm:[2,3,0,1] row_mask:0xf bank_mask:0xf
    v_add_f32_dpp v26, v26, v26 quad_perm:[2,3,0,1] row_mask:0xf bank_mask:0xf
    v_add_f32_dpp v27, v27, v27 quad_perm:[2,3,0,1] row_mask:0xf bank_mask:0xf
    s_waitcnt vmcnt(12)
    v_dot2c_f32_bf16 v8, v96, v4
    v_dot2c_f32_bf16 v9, v100, v4
    v_dot2c_f32_bf16 v10, v104, v4
    v_dot2c_f32_bf16 v11, v108, v4
    v_dot2c_f32_bf16 v8, v97, v5
    v_dot2c_f32_bf16 v9, v101, v5
    v_dot2c_f32_bf16 v10, v105, v5
    v_dot2c_f32_bf16 v11, v109, v5
L_pad21:
    s_cbranch_execz L_pad22
    v_dot2c_f32_bf16 v8, v98, v6
    v_dot2c_f32_bf16 v9, v102, v6
    v_dot2c_f32_bf16 v10, v106, v6
    v_dot2c_f32_bf16 v11, v110, v6
    v_dot2c_f32_bf16 v8, v99, v7
    v_dot2c_f32_bf16 v9, v103, v7
    v_dot2c_f32_bf16 v10, v107, v7
    v_dot2c_f32_bf16 v11, v111, v7
    s_waitcnt vmcnt(8)
    v_dot2c_f32_bf16 v12, v112, v4
    v_dot2c_f32_bf16 v13, v116, v4
    v_dot2c_f32_bf16 v14, v120, v4
    v_dot2c_f32_bf16 v15, v124, v4
    v_dot2c_f32_bf16 v12, v113, v5
    v_dot2c_f32_bf16 v13, v117, v5
    v_dot2c_f32_bf16 v14, v121, v5
    v_dot2c_f32_bf16 v15, v125, v5
    v_dot2c_f32_bf16 v12, v114, v6
    v_dot2c_f32_bf16 v13, v118, v6
    v_dot2c_f32_bf16 v14, v122, v6
    v_dot2c_f32_bf16 v15, v126, v6
    v_dot2c_f32_bf16 v12, v115, v7
    v_dot2c_f32_bf16 v13, v119, v7
    v_dot2c_f32_bf16 v14, v123, v7
    v_dot2c_f32_bf16 v15, v127, v7
    s_waitcnt vmcnt(4)
    v_dot2c_f32_bf16 v16, v128, v4
    v_dot2c_f32_bf16 v17, v132, v4
    v_dot2c_f32_bf16 v18, v136, v4
    v_dot2c_f32_bf16 v19, v140, v4
    v_dot2c_f32_bf16 v16, v129, v5
L_pad22:
    s_cbranch_execz L_pad23
    v_dot2c_f32_bf16 v17, v133, v5
    v_dot2c_f32_bf16 v18, v137, v5
    v_dot2c_f32_bf16 v19, v141, v5
    v_dot2c_f32_bf16 v16, v130, v6
    v_dot2c_f32_bf16 v17, v134, v6
    v_dot2c_f32_bf16 v18, v138, v6
    v_dot2c_f32_bf16 v19, v142, v6
    v_dot2c_f32_bf16 v16, v131, v7
    v_dot2c_f32_bf16 v17, v135, v7
    v_dot2c_f32_bf16 v18, v139, v7
    v_dot2c_f32_bf16 v19, v143, v7
    s_waitcnt vmcnt(0)
    v_dot2c_f32_bf16 v20, v144, v4
    v_dot2c_f32_bf16 v21, v148, v4
    v_dot2c_f32_bf16 v22, v152, v4
    v_dot2c_f32_bf16 v23, v156, v4
    v_dot2c_f32_bf16 v20, v145, v5
    v_dot2c_f32_bf16 v21, v149, v5
    v_dot2c_f32_bf16 v22, v153, v5
    v_dot2c_f32_bf16 v23, v157, v5
    v_dot2c_f32_bf16 v20, v146, v6
    v_dot2c_f32_bf16 v21, v150, v6
    v_dot2c_f32_bf16 v22, v154, v6
    v_dot2c_f32_bf16 v23, v158, v6
    v_dot2c_f32_bf16 v20, v147, v7
    v_dot2c_f32_bf16 v21, v151, v7
    v_dot2c_f32_bf16 v22, v155, v7
    v_dot2c_f32_bf16 v23, v159, v7
    v_add_f32_dpp v8, v8, v8 row_ror:8 row_mask:0xf bank_mask:0x3
    v_add_f32_dpp v9, v9, v9 row_ror:8 row_mask:0xf bank_mask:0x3
L_pad23:
    s_cbranch_execz L_pad24
    v_add_f32_dpp v8, v10, v10 row_ror:8 row_mask:0xf bank_mask:0xc
    v_add_f32_dpp v9, v11, v11 row_ror:8 row_mask:0xf bank_mask:0xc
    v_add_f32_dpp v12, v12, v12 row_ror:8 row_mask:0xf bank_mask:0x3
    v_add_f32_dpp v13, v13, v13 row_ror:8 row_mask:0xf bank_mask:0x3
    v_add_f32_dpp v12, v14, v14 row_ror:8 row_mask:0xf bank_mask:0xc
    v_add_f32_dpp v13, v15, v15 row_ror:8 row_mask:0xf bank_mask:0xc
    v_add_f32_dpp v16, v16, v16 row_ror:8 row_mask:0xf bank_mask:0x3
    v_add_f32_dpp v17, v17, v17 row_ror:8 row_mask:0xf bank_mask:0x3
    v_add_f32_dpp v16, v18, v18 row_ror:8 row_mask:0xf bank_mask:0xc
    v_add_f32_dpp v17, v19, v19 row_ror:8 row_mask:0xf bank_mask:0xc
    v_add_f32_dpp v20, v20, v20 row_ror:8 row_mask:0xf bank_mask:0x3
    v_add_f32_dpp v21, v21, v21 row_ror:8 row_mask:0xf bank_mask:0x3
    v_add_f32_dpp v20, v22, v22 row_ror:8 row_mask:0xf bank_mask:0xc
    v_add_f32_dpp v21, v23, v23 row_ror:8 row_mask:0xf bank_mask:0xc
    v_add_f32_dpp v28, v8, v8 row_half_mirror row_mask:0xf bank_mask:0x5
L_pad24:
    s_cbranch_execz L_pad25
    v_add_f32_dpp v28, v9, v9 row_half_mirror row_mask:0xf bank_mask:0xa
    v_add_f32_dpp v29, v12, v12 row_half_mirror row_mask:0xf bank_mask:0x5
    v_add_f32_dpp v29, v13, v13 row_half_mirror row_mask:0xf bank_mask:0xa
    v_add_f32_dpp v30, v16, v16 row_half_mirror row_mask:0xf bank_mask:0x5
    v_add_f32_dpp v30, v17, v17 row_half_mirror row_mask:0xf bank_mask:0xa
    v_add_f32_dpp v31, v20, v20 row_half_mirror row_mask:0xf bank_mask:0x5
    v_add_f32_dpp v31, v21, v21 row_half_mirror row_mask:0xf bank_mask:0xa
    v_add_f32_dpp v28, v28, v28 quad_perm:[1,0,3,2] row_mask:0xf bank_mask:0xf
    v_add_f32_dpp v29, v29, v29 quad_perm:[1,0,3,2] row_mask:0xf bank_mask:0xf
    v_add_f32_dpp v30, v30, v30 quad_perm:[1,0,3,2] row_mask:0xf bank_mask:0xf
    v_add_f32_dpp v31, v31, v31 quad_perm:[1,0,3,2] row_mask:0xf bank_mask:0xf
    v_add_f32_dpp v28, v28, v28 quad_perm:[2,3,0,1] row_mask:0xf bank_mask:0xf
    v_add_f32_dpp v29, v29, v29 quad_perm:[2,3,0,1] row_mask:0xf bank_mask:0xf
    v_add_f32_dpp v30, v30, v30 quad_perm:[2,3,0,1] row_mask:0xf bank_mask:0xf
    v_add_f32_dpp v31, v31, v31 quad_perm:[2,3,0,1] row_mask:0xf bank_mask:0xf
    s_mov_b32 s48, 0x3db504f3
L_pad25:
    s_cbranch_execz L_walk_ret
    s_mov_b32 s49, 0x3fb8aa3b
    v_cvt_pk_bf16_f32 v8, v24, v25
    v_cvt_pk_bf16_f32 v9, v26, v27
    v_cvt_pk_bf16_f32 v10, v28, v29
    v_cvt_pk_bf16_f32 v11, v30, v31
    v_lshlrev_b32 v24, 16, v8
    v_and_b32 v25, 0xffff0000, v8
    v_lshlrev_b32 v26, 16, v9
    v_and_b32 v27, 0xffff0000, v9
    v_lshlrev_b32 v28, 16, v10
    v_and_b32 v29, 0xffff0000, v10
    v_lshlrev_b32 v30, 16, v11
    v_and_b32 v31, 0xffff0000, v11
    v_mul_f32 v24, s48, v24
    v_mul_f32 v25, s48, v25
    v_mul_f32 v26, s48, v26
    v_mul_f32 v27, s48, v27
    v_mul_f32 v28, s48, v28
    v_mul_f32 v29, s48, v29
    v_mul_f32 v30, s48, v30
    v_mul_f32 v31, s48, v31
L_seg1:
L_pad26:
    s_cbranch_execz L_pad27
    v_cvt_pk_bf16_f32 v8, v24, v25
    v_cvt_pk_bf16_f32 v9, v26, v27
    v_cvt_pk_bf16_f32 v10, v28, v29
    v_cvt_pk_bf16_f32 v11, v30, v31
    v_lshlrev_b32 v24, 16, v8
    v_and_b32 v25, 0xffff0000, v8
    v_lshlrev_b32 v26, 16, v9
    v_and_b32 v27, 0xffff0000, v9
    v_lshlrev_b32 v28, 16, v10
    v_and_b32 v29, 0xffff0000, v10
    v_lshlrev_b32 v30, 16, v11
    v_and_b32 v31, 0xffff0000, v11
    v_max3_f32 v12, v24, v25, v26
    v_max3_f32 v13, v27, v28, v29
    v_max3_f32 v12, v12, v30, v31
    v_max_f32 v12, v12, v13
    s_nop 1
    v_max_f32_dpp v12, v12, v12 row_ror:4 row_mask:0xf bank_mask:0xf
    s_nop 1
L_pad27:
    s_cbranch_execz L_pad28
    v_max_f32_dpp v12, v12, v12 row_ror:8 row_mask:0xf bank_mask:0xf
    v_mov_b32 v13, v12
    s_nop 1
    v_permlane16_swap_b32 v12, v13
    v_max_f32 v12, v12, v13
    v_mov_b32 v13, v12
    s_nop 1
    v_permlane32_swap_b32 v12, v13
    v_max_f32 v12, v12, v13
    v_mul_f32 v14, s49, v12
    v_fma_f32 v24, v24, s49, -v14
    v_fma_f32 v25, v25, s49, -v14
    v_fma_f32 v26, v26, s49, -v14
    v_fma_f32 v27, v27, s49, -v14
    v_fma_f32 v28, v28, s49, -v14
    v_fma_f32 v29, v29, s49, -v14
    v_fma_f32 v30, v30, s49, -v14
    v_fma_f32 v31, v31, s49, -v14
    v_exp_f32 v24, v24
    v_exp_f32 v25, v25
    v_exp_f32 v26, v26
    v_exp_f32 v27, v27
L_pad28:
    s_cbranch_execz L_pad29
    v_exp_f32 v28, v28
    v_exp_f32 v29, v29
    v_exp_f32 v30, v30
    v_exp_f32 v31, v31
    v_lshrrev_b32 v2, 4, v0
    v_lshlrev_b32 v2, 7, v2
    v_and_b32 v3, 12, v0
    v_add_u32 v2, v2, v3
    s_lshl_b32 s13, s10, 9
    v_add_u32 v2, s13, v2
    v_cvt_pk_bf16_f32 v16, v24, v24
    v_cvt_pk_bf16_f32 v17, v25, v25
    v_cvt_pk_bf16_f32 v18, v26, v26
    v_cvt_pk_bf16_f32 v19, v27, v27
    v_cvt_pk_bf16_f32 v20, v28, v28
    v_cvt_pk_bf16_f32 v21, v29, v29
    v_cvt_pk_bf16_f32 v22, v30, v30
    v_cvt_pk_bf16_f32 v23, v31, v31
    ds_write_b32 v2, v16 offset:13312
    ds_write_b32 v2, v17 offset:13328
    ds_write_b32 v2, v18 offset:13344
L_pad29:
    s_cbranch_execz L_pad30
    ds_write_b32 v2, v19 offset:13360
    ds_write_b32 v2, v20 offset:13376
    ds_write_b32 v2, v21 offset:13392
    ds_write_b32 v2, v22 offset:13408
    ds_write_b32 v2, v23 offset:13424
    v_pk_add_f32 v[24:25], v[24:25], v[26:27]
    v_pk_add_f32 v[28:29], v[28:29], v[30:31]
    v_pk_add_f32 v[24:25], v[24:25], v[28:29]
    v_add_f32 v13, v24, v25
    s_nop 1
    v_add_f32_dpp v13, v13, v13 row_ror:4 row_mask:0xf bank_mask:0xf
    s_nop 1
    v_add_f32_dpp v13, v13, v13 row_ror:8 row_mask:0xf bank_mask:0xf
    v_mov_b32 v14, v13
    s_nop 1
    v_permlane16_swap_b32 v13, v14
    v_add_f32 v13, v13, v14
    v_mov_b32 v14, v13
    s_nop 1
    v_permlane32_swap_b32 v13, v14
L_pad30:
    s_cbranch_execz L_pad31
    v_add_f32 v13, v13, v14
    v_min_u32 v12, -2, v12
    v_min_u32 v13, -2, v13
    s_lshl_b32 s13, s10, 3
    v_mov_b32 v2, s13
    ds_write_b64 v2, v[12:13] offset:256
    s_bitcmp1_b32 s5, 0
    s_cbranch_scc0 L_k_notwo
    v_mov_b32 v5, 0
    v_lshrrev_b32 v3, 4, v0
    v_bfe_u32 v6, v0, 2, 2
    v_lshl_add_u32 v2, v3, 3, v6
    v_lshlrev_b32 v2, 7, v2
    v_and_b32 v6, 3, v0
    v_lshl_add_u32 v2, v6, 3, v2
    v_bfe_u32 v6, v0, 3, 2
    v_xor_b32 v6, s10, v6
    v_lshl_add_u32 v2, v6, 5, v2
    v_and_b32 v7, 15, v0
    v_lshlrev_b32 v72, 8, v7
    v_add_u32 v76, 0, v3
    v_xor_b32 v76, v76, v7
    v_lshl_add_u32 v76, v76, 4, v72
    v_add_u32 v77, 4, v3
L_pad31:
    s_cbranch_execz L_pad32
    v_xor_b32 v77, v77, v7
    v_lshl_add_u32 v77, v77, 4, v72
    v_add_u32 v78, 8, v3
    v_xor_b32 v78, v78, v7
    v_lshl_add_u32 v78, v78, 4, v72
    v_add_u32 v79, 12, v3
    v_xor_b32 v79, v79, v7
    v_lshl_add_u32 v79, v79, 4, v72
    s_lshl_b32 s7, s10, 2
    v_add_u32 v80, s7, v3
    v_xor_b32 v80, v80, v7
    v_lshlrev_b32 v80, 4, v80
    v_lshl_add_u32 v80, v3, 8, v80
    s_lshl_b32 s52, s10, 10
    s_mov_b32 s54, 0x000f000f
    s_lshl_b32 s54, s54, s7
    s_mov_b32 s55, s54
    v_lshlrev_b32 v6, 4, v3
    s_lshl_b32 s7, s10, 6
    v_lshl_add_u32 v73, v7, 2, s7
    v_lshlrev_b32 v74, 2, v0
    s_add_u32 s9, s61, 393216
    s_lshl_b32 s13, s62, 18
    s_lshl_b32 s49, s10, 15
L_pad32:
    s_cbranch_execz L_pad33
    s_add_u32 s13, s13, s49
    s_lshl_b32 s49, s60, 7
    s_add_u32 s13, s13, s49
    s_add_u32 s56, s24, s13
    s_addc_u32 s57, s25, 0
    s_mov_b32 s58, 162944
    s_mov_b32 s59, 0x20000
    v_lshrrev_b32 v82, 3, v0
    v_and_b32 v83, 2, v82
    v_xor_b32 v83, v83, v0
    v_and_b32 v83, 7, v83
    v_lshlrev_b32 v82, 10, v82
    v_lshl_add_u32 v82, v83, 4, v82
    v_xor_b32 v84, 64, v82
    s_lshl_b32 s49, s10, 12
    s_add_u32 m0, s49, 19456
    s_mov_b32 s48, 0
    s_mov_b32 s12, 0
    s_mov_b32 s13, -1
    s_lshl_b32 s7, s10, 2
    v_mov_b32 v83, s7
L_vd_12:
    s_sleep 2
    ds_read_b128 v[8:11], v5 offset:320
    ds_read_b32 v28, v5 offset:308
    s_add_u32 s15, s15, 1
L_pad33:
    s_cbranch_execz L_pad34
    s_cmp_gt_u32 s15, s14
    s_cbranch_scc1 L_exit
    s_waitcnt lgkmcnt(0)
    v_max3_u32 v4, v8, v9, v10
    v_max3_u32 v4, v4, v11, v28
    v_cmp_eq_u32 vcc, -1, v4
    s_cbranch_vccnz L_vd_12
    buffer_load_dwordx4 v82, s[56:59], s48 offen nt lds
    s_add_u32 m0, m0, 1024
    s_add_u32 s48, s48, 8192
    buffer_load_dwordx4 v84, s[56:59], s48 offen nt lds
    s_add_u32 m0, m0, 1024
    s_add_u32 s48, s48, 8192
    buffer_load_dwordx4 v82, s[56:59], s48 offen nt lds
    s_add_u32 m0, m0, 1024
    s_add_u32 s48, s48, 8192
    buffer_load_dwordx4 v84, s[56:59], s48 offen nt lds
    s_add_u32 m0, m0, 13312
L_pad34:
    s_cbranch_execz L_pad35
    s_add_u32 s48, s48, 106496
    buffer_load_dwordx4 v82, s[56:59], s48 offen nt lds
    s_add_u32 m0, m0, 1024
    s_add_u32 s48, s48, 8192
    buffer_load_dwordx4 v84, s[56:59], s48 offen nt lds
    s_add_u32 m0, m0, 1024
    s_add_u32 s48, s48, 8192
    buffer_load_dwordx4 v82, s[56:59], s48 offen nt lds
    s_add_u32 m0, m0, 1024
    s_add_u32 s48, s48, 8192
    buffer_load_dwordx4 v84, s[56:59], s48 offen nt lds
    s_add_u32 s7, s50, 131072
    s_setprio 3
    s_add_u32 m0, s52, 5120
    s_add_u32 s7, s7, s52
    s_waitcnt vmcnt(4)
    ds_write_b32 v83, v83 offset:336
L_wf_13:
L_pad35:
    s_cbranch_execz L_pad36
    ds_read_b128 v[8:11], v5 offset:336
    s_add_u32 s15, s15, 1
    s_cmp_gt_u32 s15, s14
    s_cbranch_scc1 L_exit
    s_waitcnt lgkmcnt(0)
    v_max3_u32 v4, v8, v9, v10
    v_max_u32 v4, v4, v11
    v_cmp_eq_u32 vcc, -1, v4
    s_cbranch_vccnz L_wf_13
    ds_read_b64_tr_b16 v[32:33], v2 offset:19456
    ds_read_b64_tr_b16 v[34:35], v2 offset:19968
    ds_read_b64_tr_b16 v[36:37], v2 offset:23552
    ds_read_b64_tr_b16 v[38:39], v2 offset:24064
    ds_read_b64_tr_b16 v[40:41], v2 offset:27648
    ds_read_b64_tr_b16 v[42:43], v2 offset:28160
    ds_read_b64_tr_b16 v[44:45], v2 offset:31744
    ds_read_b64_tr_b16 v[46:47], v2 offset:32256
    s_waitcnt vmcnt(0)
    buffer_load_dwordx4 v80, s[40:43], s7 offen sc1 lds
    ds_write_b32 v83, v83 offset:288
L_wf_14:
L_pad36:
    s_cbranch_execz L_pad37
    ds_read_b128 v[8:11], v5 offset:288
    s_add_u32 s15, s15, 1
    s_cmp_gt_u32 s15, s14
    s_cbranch_scc1 L_exit
    s_waitcnt lgkmcnt(0)
    v_max3_u32 v4, v8, v9, v10
    v_max_u32 v4, v4, v11
    v_cmp_eq_u32 vcc, -1, v4
    s_cbranch_vccnz L_wf_14
    ds_read_b64_tr_b16 v[48:49], v2 offset:35840
    ds_read_b64_tr_b16 v[50:51], v2 offset:36352
    ds_read_b64_tr_b16 v[52:53], v2 offset:39936
    ds_read_b64_tr_b16 v[54:55], v2 offset:40448
    ds_read_b64_tr_b16 v[56:57], v2 offset:44032
    ds_read_b64_tr_b16 v[58:59], v2 offset:44544
    ds_read_b64_tr_b16 v[60:61], v2 offset:48128
    ds_read_b64_tr_b16 v[62:63], v2 offset:48640
L_t1_15:
    buffer_load_dwordx4 v80, s[40:43], s7 offen sc1 lds
    s_waitcnt vmcnt(1)
L_t1s_16:
L_pad37:
    s_cbranch_execz L_pad38
    ds_read_b128 v[8:11], v76 offset:5120
    ds_read_b128 v[12:15], v77 offset:5120
    ds_read_b128 v[16:19], v78 offset:5120
    ds_read_b128 v[20:23], v79 offset:5120
    ds_read_b128 v[24:27], v6 offset:384
    s_add_u32 s15, s15, 1
    s_cmp_gt_u32 s15, s14
    s_cbranch_scc1 L_exit
    s_waitcnt lgkmcnt(1)
    v_max3_u32 v4, v8, v9, v10
    v_max3_u32 v4, v4, v11, v12
    v_max3_u32 v4, v4, v13, v14
    v_max3_u32 v4, v4, v15, v16
    v_max3_u32 v4, v4, v17, v18
    v_max3_u32 v4, v4, v19, v20
    v_max3_u32 v4, v4, v21, v22
    v_max_u32 v4, v4, v23
    v_cmp_eq_u32 vcc, -1, v4
    s_and_b64 s[98:99], vcc, s[54:55]
L_pad38:
    s_cbranch_execz L_pad39
    s_cbranch_scc1 L_t1_15
    s_cbranch_vccnz L_t1s_16
    v_mfma_f32_16x16x32_bf16 v[64:67], v[8:11], v[32:35], 0
    v_mfma_f32_16x16x32_bf16 v[68:71], v[8:11], v[48:51], 0
    v_mfma_f32_16x16x32_bf16 v[64:67], v[12:15], v[36:39], v[64:67]
    v_mfma_f32_16x16x32_bf16 v[68:71], v[12:15], v[52:55], v[68:71]
    v_mfma_f32_16x16x32_bf16 v[64:67], v[16:19], v[40:43], v[64:67]
    v_mfma_f32_16x16x32_bf16 v[68:71], v[16:19], v[56:59], v[68:71]
    v_mfma_f32_16x16x32_bf16 v[64:67], v[20:23], v[44:47], v[64:67]
    v_mfma_f32_16x16x32_bf16 v[68:71], v[20:23], v[60:63], v[68:71]
    s_waitcnt lgkmcnt(0)
    v_max3_u32 v4, v24, v25, v26
    v_max_u32 v4, v4, v27
    v_cmp_eq_u32 vcc, -1, v4
    s_cbranch_vccnz L_t1s_16
    s_nop 2
    v_cndmask_b32 v64, v64, v68, s[12:13]
    v_cndmask_b32 v65, v65, v69, s[12:13]
    v_cndmask_b32 v66, v66, v70, s[12:13]
L_pad39:
    s_cbranch_execz L_pad40
    v_cndmask_b32 v67, v67, v71, s[12:13]
    v_mul_f32 v4, v64, v24
    v_mul_f32 v5, v65, v25
    v_fmac_f32 v4, v66, v26
    v_fmac_f32 v5, v67, v27
    v_add_f32 v4, v4, v5
    v_mov_b32 v5, v4
    s_nop 1
    v_permlane16_swap_b32 v4, v5
    v_add_f32 v4, v4, v5
    v_mov_b32 v5, v4
    s_nop 1
    v_permlane32_swap_b32 v4, v5
    v_add_f32 v4, v4, v5
    v_min_u32 v4, -2, v4
    ds_write_b32 v73, v4 offset:512
    s_cmp_lg_u32 s10, 0
    s_cbranch_scc1 L_exit
L_yw_17:
    ds_read_b32 v8, v74 offset:512
    s_add_u32 s15, s15, 1
    s_cmp_gt_u32 s15, s14
    s_cbranch_scc1 L_exit
    s_waitcnt lgkmcnt(0)
    v_cmp_eq_u32 vcc, -1, v8
    s_cbranch_vccnz L_yw_17
    buffer_store_dword v8, v74, s[40:43], s9 offen sc1
    s_branch L_exit
L_vwave:
L_pad40:
    s_cbranch_execz L_pad41
    s_lshl_b32 s13, s10, 2
    v_mov_b32 v2, s13
    s_waitcnt vmcnt(32)
    ds_write_b32 v2, v2 offset:320
    v_and_b32 v2, 15, v0
    v_and_b32 v3, 1, v0
    v_lshlrev_b32 v3, 4, v3
    v_mov_b32 v4, 0xffff
    v_lshlrev_b32 v3, v3, v4
    v_lshrrev_b32 v2, 1, v2
    v_cmp_eq_u32 vcc, 0, v2
    s_nop 1
    v_cndmask_b32 v4, 0, v3, vcc
    v_cmp_eq_u32 vcc, 1, v2
    s_nop 1
    v_cndmask_b32 v5, 0, v3, vcc
    v_cmp_eq_u32 vcc, 2, v2
    s_nop 1
    v_cndmask_b32 v6, 0, v3, vcc
    v_cmp_eq_u32 vcc, 3, v2
    s_nop 1
    v_cndmask_b32 v7, 0, v3, vcc
    v_and_b32 v2, 3, v0
    v_lshlrev_b32 v2, 3, v2
L_vms_18:
    ds_read_b64 v[164:165], v2 offset:256
    s_add_u32 s15, s15, 1
    s_cmp_gt_u32 s15, s14
    s_cbranch_scc1 L_exit
L_pad41:
    s_cbranch_execz L_pad42
    s_waitcnt lgkmcnt(0)
    v_max_u32 v3, v164, v165
    v_cmp_eq_u32 vcc, -1, v3
    s_cbranch_vccnz L_vms_18
    v_lshrrev_b32 v2, 4, v0
    v_lshlrev_b32 v2, 7, v2
    s_lshl_b32 s13, s10, 9
    v_add_u32 v2, s13, v2
    ds_read_b128 v[8:11], v2 offset:13312
    ds_read_b128 v[12:15], v2 offset:13328
    ds_read_b128 v[16:19], v2 offset:13344
    ds_read_b128 v[20:23], v2 offset:13360
    v_max_f32_dpp v165, v164, v164 quad_perm:[1,0,3,2] row_mask:0xf bank_mask:0xf
    v_readlane_b32 s12, v164, s10
    s_nop 0
    v_max_f32_dpp v165, v165, v165 quad_perm:[2,3,0,1] row_mask:0xf bank_mask:0xf
    v_sub_f32 v165, s12, v165
    v_mul_f32 v165, 0x3fb8aa3b, v165
    v_exp_f32 v165, v165
    v_and_b32 v3, 15, v0
    v_lshlrev_b32 v3, 5, v3
    v_lshrrev_b32 v166, 4, v0
    v_lshl_add_u32 v3, v166, 4, v3
L_pad42:
    s_cbranch_execz L_pad43
    v_add_u32 v3, s13, v3
    s_waitcnt lgkmcnt(0)
    v_and_b32 v24, v8, v4
    v_and_b32 v25, v8, v5
    v_and_b32 v26, v8, v6
    v_and_b32 v27, v8, v7
    v_and_b32 v28, v9, v4
    v_and_b32 v29, v9, v5
    v_and_b32 v30, v9, v6
    v_and_b32 v31, v9, v7
    s_waitcnt vmcnt(31)
    v_mfma_f32_16x16x32_bf16 v[160:163], v[24:27], v[32:35], 0
    v_and_b32 v24, v10, v4
    v_and_b32 v25, v10, v5
    v_and_b32 v26, v10, v6
    v_and_b32 v27, v10, v7
    s_waitcnt vmcnt(30)
    v_mfma_f32_16x16x32_bf16 v[160:163], v[28:31], v[36:39], v[160:163]
    v_and_b32 v28, v11, v4
    v_and_b32 v29, v11, v5
    v_and_b32 v30, v11, v6
    v_and_b32 v31, v11, v7
    ds_read_b128 v[8:11], v2 offset:13376
    s_waitcnt vmcnt(29)
    v_mfma_f32_16x16x32_bf16 v[160:163], v[24:27], v[40:43], v[160:163]
    v_and_b32 v24, v12, v4
L_pad43:
    s_cbranch_execz L_pad44
    v_and_b32 v25, v12, v5
    v_and_b32 v26, v12, v6
    v_and_b32 v27, v12, v7
    s_waitcnt vmcnt(28)
    v_mfma_f32_16x16x32_bf16 v[160:163], v[28:31], v[44:47], v[160:163]
    v_and_b32 v28, v13, v4
    v_and_b32 v29, v13, v5
    v_and_b32 v30, v13, v6
    v_and_b32 v31, v13, v7
    s_waitcnt vmcnt(27)
    v_mfma_f32_16x16x32_bf16 v[160:163], v[24:27], v[48:51], v[160:163]
    v_and_b32 v24, v14, v4
    v_and_b32 v25, v14, v5
    v_and_b32 v26, v14, v6
    v_and_b32 v27, v14, v7
    s_waitcnt vmcnt(26)
    v_mfma_f32_16x16x32_bf16 v[160:163], v[28:31], v[52:55], v[160:163]
    v_and_b32 v28, v15, v4
    v_and_b32 v29, v15, v5
    v_and_b32 v30, v15, v6
    v_and_b32 v31, v15, v7
    ds_read_b128 v[12:15], v2 offset:13392
    s_waitcnt vmcnt(25)
    v_mfma_f32_16x16x32_bf16 v[160:163], v[24:27], v[56:59], v[160:163]
    v_and_b32 v24, v16, v4
    v_and_b32 v25, v16, v5
L_pad44:
    s_cbranch_execz L_pad45
    v_and_b32 v26, v16, v6
    v_and_b32 v27, v16, v7
    s_waitcnt vmcnt(24)
    v_mfma_f32_16x16x32_bf16 v[160:163], v[28:31], v[60:63], v[160:163]
    v_and_b32 v28, v17, v4
    v_and_b32 v29, v17, v5
    v_and_b32 v30, v17, v6
    v_and_b32 v31, v17, v7
    s_waitcnt vmcnt(23)
    v_mfma_f32_16x16x32_bf16 v[160:163], v[24:27], v[64:67], v[160:163]
    v_and_b32 v24, v18, v4
    v_and_b32 v25, v18, v5
    v_and_b32 v26, v18, v6
    v_and_b32 v27, v18, v7
    s_waitcnt vmcnt(22)
    v_mfma_f32_16x16x32_bf16 v[160:163], v[28:31], v[68:71], v[160:163]
    v_and_b32 v28, v19, v4
    v_and_b32 v29, v19, v5
    v_and_b32 v30, v19, v6
    v_and_b32 v31, v19, v7
    ds_read_b128 v[16:19], v2 offset:13408
    s_waitcnt vmcnt(21)
    v_mfma_f32_16x16x32_bf16 v[160:163], v[24:27], v[72:75], v[160:163]
    v_and_b32 v24, v20, v4
    v_and_b32 v25, v20, v5
    v_and_b32 v26, v20, v6
L_pad45:
    s_cbranch_execz L_pad46
    v_and_b32 v27, v20, v7
    s_waitcnt vmcnt(20)
    v_mfma_f32_16x16x32_bf16 v[160:163], v[28:31], v[76:79], v[160:163]
    v_and_b32 v28, v21, v4
    v_and_b32 v29, v21, v5
    v_and_b32 v30, v21, v6
    v_and_b32 v31, v21, v7
    s_waitcnt vmcnt(19)
    v_mfma_f32_16x16x32_bf16 v[160:163], v[24:27], v[80:83], v[160:163]
    v_and_b32 v24, v22, v4
    v_and_b32 v25, v22, v5
    v_and_b32 v26, v22, v6
    v_and_b32 v27, v22, v7
    s_waitcnt vmcnt(18)
    v_mfma_f32_16x16x32_bf16 v[160:163], v[28:31], v[84:87], v[160:163]
    v_and_b32 v28, v23, v4
    v_and_b32 v29, v23, v5
    v_and_b32 v30, v23, v6
    v_and_b32 v31, v23, v7
    ds_read_b128 v[20:23], v2 offset:13424
    s_waitcnt vmcnt(17)
    v_mfma_f32_16x16x32_bf16 v[160:163], v[24:27], v[88:91], v[160:163]
    s_waitcnt lgkmcnt(3)
    v_and_b32 v24, v8, v4
    v_and_b32 v25, v8, v5
    v_and_b32 v26, v8, v6
L_pad46:
    s_cbranch_execz L_pad47
    v_and_b32 v27, v8, v7
    s_waitcnt vmcnt(16)
    v_mfma_f32_16x16x32_bf16 v[160:163], v[28:31], v[92:95], v[160:163]
    v_and_b32 v28, v9, v4
    v_and_b32 v29, v9, v5
    v_and_b32 v30, v9, v6
    v_and_b32 v31, v9, v7
    s_waitcnt vmcnt(15)
    v_mfma_f32_16x16x32_bf16 v[160:163], v[24:27], v[96:99], v[160:163]
    v_and_b32 v24, v10, v4
    v_and_b32 v25, v10, v5
    v_and_b32 v26, v10, v6
    v_and_b32 v27, v10, v7
    s_waitcnt vmcnt(14)
    v_mfma_f32_16x16x32_bf16 v[160:163], v[28:31], v[100:103], v[160:163]
    v_and_b32 v28, v11, v4
    v_and_b32 v29, v11, v5
    v_and_b32 v30, v11, v6
    v_and_b32 v31, v11, v7
    s_waitcnt vmcnt(13)
    v_mfma_f32_16x16x32_bf16 v[160:163], v[24:27], v[104:107], v[160:163]
    s_waitcnt lgkmcnt(2)
    v_and_b32 v24, v12, v4
    v_and_b32 v25, v12, v5
    v_and_b32 v26, v12, v6
    v_and_b32 v27, v12, v7
    s_waitcnt vmcnt(12)
L_pad47:
    s_cbranch_execz L_pad48
    v_mfma_f32_16x16x32_bf16 v[160:163], v[28:31], v[108:111], v[160:163]
    v_and_b32 v28, v13, v4
    v_and_b32 v29, v13, v5
    v_and_b32 v30, v13, v6
    v_and_b32 v31, v13, v7
    s_waitcnt vmcnt(11)
    v_mfma_f32_16x16x32_bf16 v[160:163], v[24:27], v[112:115], v[160:163]
    v_and_b32 v24, v14, v4
    v_and_b32 v25, v14, v5
    v_and_b32 v26, v14, v6
    v_and_b32 v27, v14, v7
    s_waitcnt vmcnt(10)
    v_mfma_f32_16x16x32_bf16 v[160:163], v[28:31], v[116:119], v[160:163]
    v_and_b32 v28, v15, v4
    v_and_b32 v29, v15, v5
    v_and_b32 v30, v15, v6
    v_and_b32 v31, v15, v7
    s_waitcnt vmcnt(9)
    v_mfma_f32_16x16x32_bf16 v[160:163], v[24:27], v[120:123], v[160:163]
    s_waitcnt lgkmcnt(1)
    v_and_b32 v24, v16, v4
    v_and_b32 v25, v16, v5
    v_and_b32 v26, v16, v6
    v_and_b32 v27, v16, v7
    s_waitcnt vmcnt(8)
    v_mfma_f32_16x16x32_bf16 v[160:163], v[28:31], v[124:127], v[160:163]
L_pad48:
    s_cbranch_execz L_pad49
    v_and_b32 v28, v17, v4
    v_and_b32 v29, v17, v5
    v_and_b32 v30, v17, v6
    v_and_b32 v31, v17, v7
    s_waitcnt vmcnt(7)
    v_mfma_f32_16x16x32_bf16 v[160:163], v[24:27], v[128:131], v[160:163]
    v_and_b32 v24, v18, v4
    v_and_b32 v25, v18, v5
    v_and_b32 v26, v18, v6
    v_and_b32 v27, v18, v7
    s_waitcnt vmcnt(6)
    v_mfma_f32_16x16x32_bf16 v[160:163], v[28:31], v[132:135], v[160:163]
    v_and_b32 v28, v19, v4
    v_and_b32 v29, v19, v5
    v_and_b32 v30, v19, v6
    v_and_b32 v31, v19, v7
    s_waitcnt vmcnt(5)
    v_mfma_f32_16x16x32_bf16 v[160:163], v[24:27], v[136:139], v[160:163]
    s_waitcnt lgkmcnt(0)
    v_and_b32 v24, v20, v4
    v_and_b32 v25, v20, v5
    v_and_b32 v26, v20, v6
    v_and_b32 v27, v20, v7
    s_waitcnt vmcnt(4)
    v_mfma_f32_16x16x32_bf16 v[160:163], v[28:31], v[140:143], v[160:163]
    v_and_b32 v28, v21, v4
    v_and_b32 v29, v21, v5
L_pad49:
    s_cbranch_execz L_pad50
    v_and_b32 v30, v21, v6
    v_and_b32 v31, v21, v7
    s_waitcnt vmcnt(3)
    v_mfma_f32_16x16x32_bf16 v[160:163], v[24:27], v[144:147], v[160:163]
    v_and_b32 v24, v22, v4
    v_and_b32 v25, v22, v5
    v_and_b32 v26, v22, v6
    v_and_b32 v27, v22, v7
    s_waitcnt vmcnt(2)
    v_mfma_f32_16x16x32_bf16 v[160:163], v[28:31], v[148:151], v[160:163]
    v_and_b32 v28, v23, v4
    v_and_b32 v29, v23, v5
    v_and_b32 v30, v23, v6
    v_and_b32 v31, v23, v7
    s_waitcnt vmcnt(1)
    v_mfma_f32_16x16x32_bf16 v[160:163], v[24:27], v[152:155], v[160:163]
    s_waitcnt vmcnt(0)
    v_mfma_f32_16x16x32_bf16 v[160:163], v[28:31], v[156:159], v[160:163]
    s_mov_b32 exec_hi, 0
    s_nop 6
    v_mul_f32 v160, v160, v165
    v_mul_f32 v161, v161, v165
    v_mul_f32 v162, v162, v165
    v_mul_f32 v163, v163, v165
    v_min_u32 v160, -2, v160
    v_min_u32 v161, -2, v161
    v_min_u32 v162, -2, v162
L_pad50:
    s_cbranch_execz L_pad51
    v_min_u32 v163, -2, v163
    ds_write_b128 v3, v[160:163] offset:3072
    s_branch L_exit
L_k_notwo:
    s_cmp_ge_u32 s11, 43
    s_cbranch_scc1 L_exit
    s_branch L_t2
L_h2:
    s_cmp_lt_u32 s11, 43
    s_cbranch_scc1 L_t2
    s_cmp_eq_u32 s3, 2
    s_cbranch_scc0 L_exit
L_t0:
    v_lshlrev_b32 v142, 3, v0
    v_lshlrev_b32 v143, 2, v0
    s_and_b32 s7, s6, 15
    s_lshl_b32 s7, s7, 8
    s_add_u32 s7, s7, s50
    s_add_u32 s7, s7, 131072
    v_mov_b32 v153, 0
L_h2w_19:
    s_sleep 16
    ds_read_b32 v144, v153 offset:320
    ds_read_b32 v145, v153 offset:308
    s_add_u32 s15, s15, 1
    s_cmp_gt_u32 s15, s14
    s_cbranch_scc1 L_exit
    s_waitcnt lgkmcnt(0)
    v_max_u32 v152, v144, v145
    v_cmp_eq_u32 vcc, -1, v152
    s_cbranch_vccnz L_h2w_19
L_pad51:
    s_cbranch_execz L_walk_ret
    v_readfirstlane_b32 s8, v145
L_ow_20:
    ds_read_b64 v[144:145], v142 offset:3072
    ds_read_b64 v[146:147], v142 offset:3584
    ds_read_b64 v[148:149], v142 offset:4096
    ds_read_b64 v[150:151], v142 offset:4608
    s_add_u32 s15, s15, 1
    s_cmp_gt_u32 s15, s14
    s_cbranch_scc1 L_exit
    s_waitcnt lgkmcnt(0)
    v_max3_u32 v152, v144, v145, v146
    v_max3_u32 v152, v152, v147, v148
    v_max3_u32 v152, v152, v149, v150
    v_max_u32 v152, v152, v151
    v_cmp_eq_u32 vcc, -1, v152
    s_cbranch_vccnz L_ow_20
    v_pk_add_f32 v[144:145], v[144:145], v[146:147]
    v_pk_add_f32 v[148:149], v[148:149], v[150:151]
    v_pk_add_f32 v[144:145], v[144:145], v[148:149]
    v_cvt_pk_bf16_f32 v144, v144, v145
    v_min_u32 v144, -2, v144
L_seg2:
L_pad52:
    s_cbranch_execz L_pad53
    s_cmp_eq_u32 s8, 0
    s_cbranch_scc1 L_op_far
    buffer_store_dword v144, v143, s[40:43], s7 offen
    s_branch L_op_done
L_op_far:
    buffer_store_dword v144, v143, s[40:43], s7 offen sc1
L_op_done:
    ds_write_b32 v153, v153 offset:352
    s_cmp_lt_u32 s11, 43
    s_cbranch_scc1 L_t2_nostage
    s_branch L_exit
L_h_done:
    s_cmp_ge_u32 s11, 43
    s_cbranch_scc1 L_exit
L_t2:
    v_lshrrev_b32 v3, 4, v0
    v_and_b32 v2, 15, v0
    v_lshl_add_u32 v4, v2, 2, v3
    s_lshl_b32 s7, s3, 6
    v_add_u32 v4, s7, v4
    v_lshlrev_b32 v80, 1, v4
    global_load_ushort v81, v80, s[16:17]
    v_and_b32 v5, 31, v0
    s_lshl_b32 s7, s11, 5
    v_add_u32 v6, s7, v5
    v_lshlrev_b32 v6, 1, v6
    global_load_ushort v82, v6, s[30:31]
    s_and_b32 s7, s11, 15
    s_lshl_b32 s7, s7, 5
L_pad53:
    s_cbranch_execz L_pad54
    v_and_b32 v6, 7, v0
    v_lshl_add_u32 v6, v6, 2, v3
    v_add_u32 v6, s7, v6
    v_lshlrev_b32 v83, 1, v6
    global_load_ushort v84, v83, s[34:35]
    v_lshrrev_b32 v6, 5, v0
    v_mul_u32_u24 v6, 5504, v6
    v_lshl_add_u32 v6, v5, 2, v6
    v_mov_b32 v93, 0
    v_bfe_u32 v7, v0, 2, 2
    v_lshl_add_u32 v7, v3, 3, v7
    v_and_b32 v8, 3, v0
    v_lshlrev_b32 v8, 3, v8
    v_lshl_add_u32 v9, v7, 6, v8
    s_lshl_b32 s7, s3, 12
    v_add_u32 v9, s7, v9
    v_mul_u32_u24 v95, 1056, v7
    v_add_u32 v95, v95, v8
    s_lshl_b32 s7, s3, 8
    s_add_u32 s7, s7, 52224
    v_add_u32 v95, s7, v95
    v_lshlrev_b32 v87, 10, v3
L_pad54:
    s_cbranch_execz L_pad55
    v_lshl_add_u32 v87, v2, 4, v87
    s_mov_b32 s51, 0
    v_mov_b32 v12, 0x3f803f80
    v_mov_b32 v13, 0x3f803f80
    v_mov_b32 v14, 0x3f803f80
    v_mov_b32 v15, 0x3f803f80
    s_mov_b32 s12, 0xffff0000
    s_mov_b32 s13, 0xffff0000
    v_lshlrev_b32 v85, 5, v5
    s_lshl_b32 s7, s3, 2
    v_add_u32 v86, s7, v85
    s_lshl_b32 s48, s3, 12
    s_add_u32 s48, s48, 393216
    v_lshlrev_b32 v88, 4, v3
    s_lshl_b32 s7, s3, 7
    v_add_u32 v89, s7, v88
    s_lshl_b32 s7, s3, 6
    v_lshl_add_u32 v90, v5, 1, s7
    v_add_u32 v91, s7, v88
    v_lshrrev_b32 v92, 5, v0
    v_lshlrev_b32 v92, 2, v92
    s_lshl_b32 s7, s3, 3
L_pad55:
    s_cbranch_execz L_pad56
    v_add_u32 v92, s7, v92
    s_lshl_b32 s52, s11, 7
    s_mul_i32 s7, s3, 22016
    s_add_u32 s52, s52, s7
    s_add_u32 s52, s52, 458752
    s_mov_b32 s54, 0
    s_mov_b32 s55, -1
    s_mul_i32 s7, s11, 5504
    s_add_u32 s7, s7, 458752
    s_add_u32 s56, s40, s7
    s_addc_u32 s57, s41, 0
    s_mov_b32 s58, 5504
    s_mov_b32 s59, 0x20000
    v_add_u32 v96, 0x1000, v1
    s_lshl_b32 s7, s10, 2
    v_mov_b32 v11, s7
    s_waitcnt vmcnt(0)
    v_lshlrev_b32 v81, 16, v81
    v_lshlrev_b32 v82, 16, v82
    v_lshlrev_b32 v84, 16, v84
    s_mov_b32 s63, s48
    s_cmp_eq_u32 s3, 2
    s_cbranch_scc1 L_t0
    s_cmp_lt_u32 s3, 4
L_pad56:
    s_cbranch_execz L_pad57
    s_cbranch_scc1 L_t2_nostage
    s_setprio 0
    v_mov_b32 v5, 0
L_vd_21:
    s_sleep 4
    ds_read_b128 v[16:19], v5 offset:320
    s_add_u32 s15, s15, 1
    s_cmp_gt_u32 s15, s14
    s_cbranch_scc1 L_exit
    s_waitcnt lgkmcnt(0)
    v_max3_u32 v4, v16, v17, v18
    v_max_u32 v4, v4, v19
    v_cmp_eq_u32 vcc, -1, v4
    s_cbranch_vccnz L_vd_21
    s_lshl_b32 s13, s11, 6
    s_mul_i32 s49, s10, 352256
    s_add_u32 s13, s13, s49
    s_add_u32 s44, s28, s13
    s_addc_u32 s45, s29, 0
    s_mov_b32 s46, 349568
    s_mov_b32 s47, 0x20000
    v_lshrrev_b32 v2, 2, v0
    v_mul_u32_u24 v2, 2752, v2
    v_and_b32 v3, 3, v0
    v_lshl_add_u32 v2, v3, 4, v2
L_pad57:
    s_cbranch_execz L_pad58
    s_lshl_b32 s49, s10, 13
    s_add_u32 m0, s49, 19456
    s_mov_b32 s48, 0
    buffer_load_dwordx4 v2, s[44:47], s48 offen nt lds
    s_add_u32 m0, m0, 0x400
    s_add_u32 s48, s48, 44032
    buffer_load_dwordx4 v2, s[44:47], s48 offen nt lds
    s_add_u32 m0, m0, 0x400
    s_add_u32 s48, s48, 44032
    buffer_load_dwordx4 v2, s[44:47], s48 offen nt lds
    s_add_u32 m0, m0, 0x400
    s_add_u32 s48, s48, 44032
    buffer_load_dwordx4 v2, s[44:47], s48 offen nt lds
    s_add_u32 m0, m0, 0x400
    s_add_u32 s48, s48, 44032
    buffer_load_dwordx4 v2, s[44:47], s48 offen nt lds
    s_add_u32 m0, m0, 0x400
L_pad58:
    s_cbranch_execz L_pad59
    s_add_u32 s48, s48, 44032
L_opd_22:
    s_sleep 1
    ds_read_b32 v8, v5 offset:352
    s_add_u32 s15, s15, 1
    s_cmp_gt_u32 s15, s14
    s_cbranch_scc1 L_exit
    s_waitcnt lgkmcnt(0)
    v_cmp_eq_u32 vcc, -1, v8
    s_cbranch_vccnz L_opd_22
    buffer_load_dwordx4 v2, s[44:47], s48 offen nt lds
    s_add_u32 m0, m0, 0x400
    s_add_u32 s48, s48, 44032
    buffer_load_dwordx4 v2, s[44:47], s48 offen nt lds
    s_add_u32 m0, m0, 0x400
    s_add_u32 s48, s48, 44032
    buffer_load_dwordx4 v2, s[44:47], s48 offen nt lds
    s_lshl_b32 s13, s11, 15
    s_lshl_b32 s49, s10, 13
    s_add_u32 s13, s13, s49
    s_add_u32 s44, s32, s13
    s_addc_u32 s45, s33, 0
L_pad59:
    s_cbranch_execz L_pad60
    s_mov_b32 s46, 0x2000
    s_mul_i32 s49, s10, 8448
    s_add_u32 m0, s49, 52224
    s_mov_b32 s48, 0
    buffer_load_dwordx4 v1, s[44:47], s48 offen nt lds
    s_add_u32 m0, m0, 1056
    s_addk_i32 s48, 0x400
    buffer_load_dwordx4 v1, s[44:47], s48 offen nt lds
    s_add_u32 m0, m0, 1056
    s_addk_i32 s48, 0x400
    buffer_load_dwordx4 v1, s[44:47], s48 offen nt lds
    s_add_u32 m0, m0, 1056
    s_addk_i32 s48, 0x400
    buffer_load_dwordx4 v1, s[44:47], s48 offen nt lds
    s_add_u32 m0, m0, 1056
    s_addk_i32 s48, 0x400
    buffer_load_dwordx4 v1, s[44:47], s48 offen nt lds
    s_add_u32 m0, m0, 1056
L_pad60:
    s_cbranch_execz L_pad61
    s_addk_i32 s48, 0x400
    buffer_load_dwordx4 v1, s[44:47], s48 offen nt lds
    s_add_u32 m0, m0, 1056
    s_addk_i32 s48, 0x400
    buffer_load_dwordx4 v1, s[44:47], s48 offen nt lds
    s_add_u32 m0, m0, 1056
    s_addk_i32 s48, 0x400
    buffer_load_dwordx4 v1, s[44:47], s48 offen nt lds
    s_mov_b32 s13, s12
    s_mov_b32 s51, 1
    s_waitcnt vmcnt(8)
    ds_write_b32 v11, v11 offset:288
L_t2_nostage:
    s_setprio 3
L_wf_23:
    s_sleep 1
    ds_read_b128 v[16:19], v93 offset:288
    ds_read_b32 v20, v93 offset:308
    s_add_u32 s15, s15, 1
    s_cmp_gt_u32 s15, s14
    s_cbranch_scc1 L_exit
    s_waitcnt lgkmcnt(0)
    v_max3_u32 v21, v16, v17, v18
    v_max3_u32 v21, v21, v19, v20
L_pad61:
    s_cbranch_execz L_pad62
    v_cmp_eq_u32 vcc, -1, v21
    s_cbranch_vccnz L_wf_23
    ds_read_b64_tr_b16 v[32:33], v9 offset:19456
    ds_read_b64_tr_b16 v[34:35], v9 offset:19712
    ds_read_b64_tr_b16 v[36:37], v9 offset:19488
    ds_read_b64_tr_b16 v[38:39], v9 offset:19744
    ds_read_b64_tr_b16 v[40:41], v9 offset:21504
    ds_read_b64_tr_b16 v[42:43], v9 offset:21760
    ds_read_b64_tr_b16 v[44:45], v9 offset:21536
    ds_read_b64_tr_b16 v[46:47], v9 offset:21792
    s_waitcnt lgkmcnt(0)
    v_mfma_f32_16x16x32_bf16 v[64:67], v[12:15], v[32:35], 0
    v_mfma_f32_16x16x32_bf16 v[68:71], v[12:15], v[36:39], 0
    v_mfma_f32_16x16x32_bf16 v[64:67], v[12:15], v[40:43], v[64:67]
    v_mfma_f32_16x16x32_bf16 v[68:71], v[12:15], v[44:47], v[68:71]
    s_nop 7
    v_cndmask_b32 v64, v64, v68, s[12:13]
L_pad62:
    s_cbranch_execz L_pad63
    ds_write_b32 v86, v64 offset:17408
    s_cmp_lt_u32 s3, 4
    s_cbranch_scc1 L_t2_h
    s_waitcnt vmcnt(0)
    ds_write_b32 v11, v11 offset:336
L_t2_h:
L_t2_24:
    buffer_load_dwordx4 v[100:103], v87, s[40:43], s63 offen offset:0 sc1
    buffer_load_dwordx4 v[104:107], v87, s[40:43], s63 offen offset:256 sc1
    buffer_load_dwordx4 v[108:111], v87, s[40:43], s63 offen offset:512 sc1
    buffer_load_dwordx4 v[112:115], v87, s[40:43], s63 offen offset:768 sc1
    s_add_u32 s15, s15, 1
    s_cmp_gt_u32 s15, s14
    s_cbranch_scc1 L_exit
    s_cmp_lg_u32 s51, 0
    s_cbranch_scc1 L_t2k_26
    ds_read_b128 v[16:19], v93 offset:336
    s_waitcnt lgkmcnt(0)
    v_max3_u32 v21, v16, v17, v18
    v_max_u32 v21, v21, v19
    v_cmp_eq_u32 vcc, -1, v21
    s_cbranch_vccnz L_t2k_26
    s_mov_b32 s51, 1
    s_mov_b64 s[98:99], exec
    s_mov_b64 exec, -1
L_pad63:
    s_cbranch_execz L_pad64
    ds_read_b64_tr_b16 v[120:121], v95 offset:0
    ds_read_b64_tr_b16 v[122:123], v95 offset:4224
    ds_read_b64_tr_b16 v[124:125], v95 offset:32
    ds_read_b64_tr_b16 v[126:127], v95 offset:4256
    ds_read_b64_tr_b16 v[128:129], v95 offset:64
    ds_read_b64_tr_b16 v[130:131], v95 offset:4288
    ds_read_b64_tr_b16 v[132:133], v95 offset:96
    ds_read_b64_tr_b16 v[134:135], v95 offset:4320
    ds_read_b64_tr_b16 v[136:137], v95 offset:128
    ds_read_b64_tr_b16 v[138:139], v95 offset:4352
    ds_read_b64_tr_b16 v[140:141], v95 offset:160
    ds_read_b64_tr_b16 v[142:143], v95 offset:4384
    ds_read_b64_tr_b16 v[144:145], v95 offset:192
    ds_read_b64_tr_b16 v[146:147], v95 offset:4416
    ds_read_b64_tr_b16 v[148:149], v95 offset:224
    ds_read_b64_tr_b16 v[150:151], v95 offset:4448
L_pad64:
    s_cbranch_execz L_pad65
    s_mov_b64 exec, s[98:99]
L_t2k_26:
    s_waitcnt vmcnt(0)
    v_max3_u32 v4, v100, v101, v102
    v_max3_u32 v4, v4, v103, v104
    v_max3_u32 v4, v4, v105, v106
    v_max3_u32 v4, v4, v107, v108
    v_max3_u32 v4, v4, v109, v110
    v_max3_u32 v4, v4, v111, v112
    v_max3_u32 v4, v4, v113, v114
    v_max_u32 v4, v4, v115
    v_cmp_eq_u32 vcc, -1, v4
    s_cbranch_vccz L_t2d_25
    s_mov_b64 exec, vcc
    s_branch L_t2_24
L_t2d_25:
    s_mov_b64 exec, -1
    v_pk_add_f32 v[8:9], v[100:101], v[104:105]
    v_pk_add_f32 v[10:11], v[102:103], v[106:107]
    v_pk_add_f32 v[16:17], v[108:109], v[112:113]
    v_pk_add_f32 v[18:19], v[110:111], v[114:115]
L_pad65:
    s_cbranch_execz L_pad66
    v_pk_add_f32 v[8:9], v[8:9], v[16:17]
    v_pk_add_f32 v[10:11], v[10:11], v[18:19]
    s_nop 1
    v_permlane32_swap_b32 v8, v10
    v_permlane32_swap_b32 v9, v11
    v_pk_add_f32 v[8:9], v[8:9], v[10:11]
    s_nop 1
    v_permlane16_swap_b32 v8, v9
    v_add_f32 v8, v8, v9
    v_cvt_pk_bf16_f32 v8, 0, v8
    v_add_f32 v8, v8, v81
    v_cvt_pk_bf16_f32 v8, 0, v8
    ds_write_b16_d16_hi v80, v8 offset:15360
    ds_read_b128 v[12:15], v89 offset:15360
    ds_read_b128 v[16:19], v89 offset:15424
    v_mul_f32 v9, v8, v8
    s_nop 1
    v_permlane32_swap_b32 v8, v9
    v_add_f32 v8, v8, v9
    s_nop 1
    v_add_f32_dpp v8, v8, v8 quad_perm:[1,0,3,2] row_mask:0xf bank_mask:0xf
    s_nop 1
L_pad66:
    s_cbranch_execz L_pad67
    v_add_f32_dpp v8, v8, v8 quad_perm:[2,3,0,1] row_mask:0xf bank_mask:0xf
    s_nop 1
    v_add_f32_dpp v8, v8, v8 row_ror:4 row_mask:0xf bank_mask:0xf
    s_nop 1
    v_add_f32_dpp v8, v8, v8 row_ror:8 row_mask:0xf bank_mask:0xf
    v_mov_b32 v9, v8
    s_nop 1
    v_permlane16_swap_b32 v8, v9
    v_add_f32 v8, v8, v9
    s_waitcnt lgkmcnt(0)
    v_mfma_f32_16x16x32_bf16 v[64:67], v[12:15], v[32:35], 0
    v_mfma_f32_16x16x32_bf16 v[68:71], v[12:15], v[36:39], 0
    v_mfma_f32_16x16x32_bf16 v[64:67], v[16:19], v[40:43], v[64:67]
    v_mfma_f32_16x16x32_bf16 v[68:71], v[16:19], v[44:47], v[68:71]
    ds_write_b32 v92, v8 offset:18432
    s_nop 6
    v_cndmask_b32 v64, v64, v68, s[12:13]
    ds_write_b32 v86, v64 offset:16384
    s_waitcnt lgkmcnt(0)
    s_barrier
    s_cmp_ge_u32 s3, 4
L_pad67:
    s_cbranch_execz L_pad68
    s_cbranch_scc1 L_t3
    ds_read_b128 v[16:19], v93 offset:18432
    ds_read_b128 v[20:23], v93 offset:18448
    ds_read_b128 v[24:27], v93 offset:18464
    ds_read_b128 v[28:31], v93 offset:18480
    ds_read_b128 v[8:11], v85 offset:16384
    ds_read_b128 v[12:15], v85 offset:16400
    ds_read_b128 v[64:67], v85 offset:17408
    ds_read_b128 v[68:71], v85 offset:17424
    s_waitcnt lgkmcnt(4)
    v_pk_add_f32 v[16:17], v[16:17], v[18:19]
    v_pk_add_f32 v[20:21], v[20:21], v[22:23]
    v_pk_add_f32 v[24:25], v[24:25], v[26:27]
    v_pk_add_f32 v[28:29], v[28:29], v[30:31]
    v_pk_add_f32 v[16:17], v[16:17], v[20:21]
    v_pk_add_f32 v[24:25], v[24:25], v[28:29]
    v_pk_add_f32 v[16:17], v[16:17], v[24:25]
L_pad68:
    s_cbranch_execz L_pad69
    v_mul_f32 v16, 0x3b000000, v16
    v_mul_f32 v17, 0x3b000000, v17
    v_fma_f32 v17, -v16, v16, v17
    v_max_f32 v17, 0, v17
    v_cvt_pk_bf16_f32 v17, 0, v17
    v_add_f32 v17, 0x3727c5ac, v17
    v_cvt_pk_bf16_f32 v17, 0, v17
    v_sqrt_f32 v17, v17
    v_cvt_pk_bf16_f32 v16, 0, v16
    s_waitcnt lgkmcnt(0)
    s_cmp_lg_u32 s51, 0
    s_cbranch_scc1 L_t2_havew2
    ds_read_b64_tr_b16 v[120:121], v95 offset:0
    ds_read_b64_tr_b16 v[122:123], v95 offset:4224
    ds_read_b64_tr_b16 v[124:125], v95 offset:32
    ds_read_b64_tr_b16 v[126:127], v95 offset:4256
    ds_read_b64_tr_b16 v[128:129], v95 offset:64
    ds_read_b64_tr_b16 v[130:131], v95 offset:4288
L_pad69:
    s_cbranch_execz L_pad70
    ds_read_b64_tr_b16 v[132:133], v95 offset:96
    ds_read_b64_tr_b16 v[134:135], v95 offset:4320
    ds_read_b64_tr_b16 v[136:137], v95 offset:128
    ds_read_b64_tr_b16 v[138:139], v95 offset:4352
    ds_read_b64_tr_b16 v[140:141], v95 offset:160
    ds_read_b64_tr_b16 v[142:143], v95 offset:4384
    ds_read_b64_tr_b16 v[144:145], v95 offset:192
    ds_read_b64_tr_b16 v[146:147], v95 offset:4416
    ds_read_b64_tr_b16 v[148:149], v95 offset:224
    ds_read_b64_tr_b16 v[150:151], v95 offset:4448
L_t2_havew2:
    v_pk_add_f32 v[8:9], v[8:9], v[10:11]
    v_pk_add_f32 v[12:13], v[12:13], v[14:15]
    v_cvt_pk_bf16_f32 v17, 0, v17
    v_rcp_f32 v17, v17
    v_pk_add_f32 v[64:65], v[64:65], v[66:67]
    v_pk_add_f32 v[68:69], v[68:69], v[70:71]
L_pad70:
    s_cbranch_execz L_pad71
    v_pk_add_f32 v[8:9], v[8:9], v[12:13]
    v_pk_add_f32 v[64:65], v[64:65], v[68:69]
    v_add_f32 v8, v8, v9
    v_add_f32 v64, v64, v65
    v_fma_f32 v8, -v16, v64, v8
    v_mul_f32 v8, v8, v17
    v_cvt_pk_bf16_f32 v8, 0, v8
    v_add_f32 v8, v8, v82
    v_cvt_pk_bf16_f32 v8, 0, v8
    v_mul_f32 v9, v8, v8
    v_mov_b32 v10, 0xc0135761
    v_fmac_f32 v10, 0xbdd2d3e8, v9
    v_mul_f32 v9, v10, v8
    v_exp_f32 v9, v9
    s_nop 0
    v_add_f32 v9, 1.0, v9
    v_rcp_f32 v9, v9
    s_nop 0
    v_mul_f32 v8, v8, v9
    v_cvt_pk_bf16_f32 v8, v8, v8
    ds_write_b16 v90, v8 offset:18560
L_pad71:
    s_cbranch_execz L_pad72
    ds_read_b128 v[12:15], v91 offset:18560
    s_waitcnt lgkmcnt(0)
    v_mfma_f32_16x16x32_bf16 v[32:35], v[12:15], v[120:123], 0
    v_mfma_f32_16x16x32_bf16 v[36:39], v[12:15], v[124:127], 0
    v_mfma_f32_16x16x32_bf16 v[40:43], v[12:15], v[128:131], 0
    v_mfma_f32_16x16x32_bf16 v[44:47], v[12:15], v[132:135], 0
    v_mfma_f32_16x16x32_bf16 v[48:51], v[12:15], v[136:139], 0
    v_mfma_f32_16x16x32_bf16 v[52:55], v[12:15], v[140:143], 0
    v_mfma_f32_16x16x32_bf16 v[56:59], v[12:15], v[144:147], 0
    v_mfma_f32_16x16x32_bf16 v[60:63], v[12:15], v[148:151], 0
    s_add_u32 s53, s52, 11008
    s_nop 0
    v_cndmask_b32 v32, v32, v36, s[12:13]
    s_nop 0
    v_cndmask_b32 v40, v40, v44, s[12:13]
    v_cndmask_b32 v32, v32, v40, s[54:55]
    v_min_u32 v32, -2, v32
    buffer_store_dword v32, v6, s[40:43], s52 offen sc1
L_pad72:
    s_cbranch_execz L_pad73
    v_cndmask_b32 v48, v48, v52, s[12:13]
    v_cndmask_b32 v56, v56, v60, s[12:13]
    v_cndmask_b32 v48, v48, v56, s[54:55]
    v_min_u32 v48, -2, v48
    buffer_store_dword v48, v6, s[40:43], s53 offen sc1
    s_branch L_exit
L_t3:
    s_cmp_lg_u32 s3, 4
    s_cbranch_scc1 L_exit
    s_cmp_ge_u32 s11, 16
    s_cbranch_scc1 L_exit
    ds_read_u16 v99, v83 offset:15360
    s_mov_b32 s54, 0x00ff00ff
    s_mov_b32 s55, 0x00ff00ff
    v_mov_b32 v120, -1
    v_mov_b32 v121, -1
    v_mov_b32 v122, -1
    v_mov_b32 v123, -1
    v_mov_b32 v124, -1
    v_mov_b32 v125, -1
    v_mov_b32 v126, -1
    v_mov_b32 v127, -1
    v_mov_b32 v128, -1
    v_mov_b32 v129, -1
L_pad73:
    s_cbranch_execz L_pad74
    v_mov_b32 v130, -1
    v_mov_b32 v131, -1
    v_mov_b32 v132, -1
    v_mov_b32 v133, -1
    v_mov_b32 v134, -1
    v_mov_b32 v135, -1
    v_mov_b32 v136, -1
    v_mov_b32 v137, -1
    v_mov_b32 v138, -1
    v_mov_b32 v139, -1
    v_mov_b32 v140, -1
    v_mov_b32 v141, -1
    v_mov_b32 v142, -1
    v_mov_b32 v143, -1
L_t3_27:
    buffer_load_dwordx4 v[120:123], v1, s[56:59], 0 offen offset:0 sc1
    buffer_load_dwordx4 v[124:127], v1, s[56:59], 0 offen offset:1024 sc1
    buffer_load_dwordx4 v[128:131], v1, s[56:59], 0 offen offset:2048 sc1
    buffer_load_dwordx4 v[132:135], v1, s[56:59], 0 offen offset:3072 sc1
    buffer_load_dwordx4 v[136:139], v96, s[56:59], 0 offen offset:0 sc1
    buffer_load_dwordx4 v[140:143], v96, s[56:59], 0 offen offset:1024 sc1
    s_add_u32 s15, s15, 1
    s_cmp_gt_u32 s15, s14
    s_cbranch_scc1 L_exit
    s_waitcnt vmcnt(12)
    v_max3_u32 v4, v120, v121, v122
L_pad74:
    s_cbranch_execz L_pad75
    v_max3_u32 v4, v4, v123, v124
    v_max3_u32 v4, v4, v125, v126
    v_max3_u32 v4, v4, v127, v128
    v_max3_u32 v4, v4, v129, v130
    v_max3_u32 v4, v4, v131, v132
    v_max3_u32 v4, v4, v133, v134
    v_max3_u32 v4, v4, v135, v136
    v_max3_u32 v4, v4, v137, v138
    v_max3_u32 v4, v4, v139, v140
    v_max3_u32 v4, v4, v141, v142
    v_max_u32 v4, v4, v143
    v_cmp_eq_u32 vcc, -1, v4
    s_cbranch_vccz L_t3d_28
    s_mov_b64 exec, vcc
    s_branch L_t3_27
L_t3d_28:
    s_mov_b64 exec, -1
    v_pk_add_f32 v[8:9], v[120:121], v[124:125]
    v_pk_add_f32 v[10:11], v[122:123], v[126:127]
L_pad75:
    s_cbranch_execz L_pad76
    v_pk_add_f32 v[12:13], v[128:129], v[132:133]
    v_pk_add_f32 v[14:15], v[130:131], v[134:135]
    v_pk_add_f32 v[16:17], v[136:137], v[140:141]
    v_pk_add_f32 v[18:19], v[138:139], v[142:143]
    v_pk_add_f32 v[8:9], v[8:9], v[12:13]
    v_pk_add_f32 v[10:11], v[10:11], v[14:15]
    v_pk_add_f32 v[8:9], v[8:9], v[16:17]
    v_pk_add_f32 v[10:11], v[10:11], v[18:19]
    s_nop 1
    v_permlane32_swap_b32 v8, v10
    v_permlane32_swap_b32 v9, v11
    v_pk_add_f32 v[8:9], v[8:9], v[10:11]
    s_nop 1
    v_permlane16_swap_b32 v8, v9
    v_add_f32 v8, v8, v9
    s_nop 1
    v_add_f32_dpp v8, v8, v8 row_ror:8 row_mask:0xf bank_mask:0xf
    v_cvt_pk_bf16_f32 v8, 0, v8
    v_add_f32 v8, v8, v84
    v_cvt_pk_bf16_f32 v8, 0, v8
L_pad76:
    s_cbranch_execz L_pad77
    s_waitcnt lgkmcnt(0)
    v_lshlrev_b32 v99, 16, v99
    v_add_f32 v8, v8, v99
    v_cvt_pk_bf16_f32 v8, v8, v8
    s_mov_b64 exec, s[54:55]
    global_store_short v83, v8, s[36:37]
L_pad77:
    s_cbranch_execz L_walk_ret
L_exit:
L_end:
    s_endpgm
.section .rodata,"a"
.p2align 6
.amdhsa_kernel sequential_preLN__sliding_block_cached__dense_activation_gelu__decode_kernel
  .amdhsa_next_free_vgpr 168
  .amdhsa_next_free_sgpr 100
  .amdhsa_accum_offset 168
  .amdhsa_group_segment_fixed_size 0
  .amdhsa_kernarg_size 104
  .amdhsa_user_sgpr_count 2
  .amdhsa_user_sgpr_kernarg_segment_ptr 1
  .amdhsa_system_sgpr_workgroup_id_x 1
  .amdhsa_float_denorm_mode_32 3
.end_amdhsa_kernel
```
